```python
import torch

def _softmax(x, axis=-1):
    return torch.softmax(x, dim=axis)

def _gelu(x):
    return torch.nn.functional.gelu(x, approximate='tanh')

def _silu(x):
    return torch.nn.functional.silu(x)

def _sigmoid(x):
    return torch.sigmoid(x)

def _layernorm(x, axis=-1, eps=1e-05):
    m = x.mean(dim=axis, keepdim=True)
    v = x.var(dim=axis, keepdim=True, unbiased=False)
    return (x - m) / torch.sqrt(v + eps)

def _scatter_add(tgt, idx, src, axis=0):
    return tgt.clone().index_add_(axis, idx, src)

def _segment_sum(src, seg, n):
    out = torch.zeros((n,) + src.shape[1:], dtype=src.dtype)
    return out.index_add_(0, seg, src)

def _pad(x, pw):
    flat = tuple((v for pair in reversed(pw) for v in pair))
    return torch.nn.functional.pad(x, flat)
kernel_name = 'gated_mix__mha_block__mixer_gmlp__prompt'

def setup_inputs():

    _w = lambda a: (lambda t: t.to(torch.bfloat16) if t.is_floating_point() else t)(torch.as_tensor(a))

    def _A_setup():
        B, S, D, H = (1, 2048, 512, 32)
        return {'x': _w((lambda *s: torch.randn(*s, dtype=torch.bfloat16) * 0.05)(B, S, D)), 'wqkv': _w((lambda *s: torch.randn(*s, dtype=torch.bfloat16) * 1.6)(D, 3 * D)), 'wo': _w((lambda *s: torch.randn(*s, dtype=torch.bfloat16) * 0.1)(D, D))}
    _A_in = _A_setup()

    def _B_setup():
        B, S, D, F = (1, 2048, 512, 1792)
        Fh = F // 2
        return {'x': _w((lambda *s: torch.randn(*s, dtype=torch.bfloat16) * 0.05)(B, S, D)), 'w_in': _w((lambda *s: torch.randn(*s, dtype=torch.bfloat16) * 0.8)(D, 2 * Fh)), 'w_sp': _w(0.01 * (lambda *s: torch.randn(*s, dtype=torch.bfloat16) * 0.8)(S, S)), 'b_sp': _w(1.0 + 0.01 * (lambda *s: torch.randn(*s, dtype=torch.bfloat16) * 0.05)(S)), 'w_out': _w((lambda *s: torch.randn(*s, dtype=torch.bfloat16) * 0.05)(Fh, D))}
    _B_in = _B_setup()
    return {'A_x': _A_in['x'], 'A_wqkv': _A_in['wqkv'], 'A_wo': _A_in['wo'], 'B_x': _B_in['x'], 'B_w_in': _B_in['w_in'], 'B_w_sp': _B_in['w_sp'], 'B_b_sp': _B_in['b_sp'], 'B_w_out': _B_in['w_out'], 'gate_w': _w((lambda *s: torch.randn(*s, dtype=torch.bfloat16) * 0.05)(512) * 16.0)}

def reference(A_x, A_wqkv, A_wo, B_x, B_w_in, B_w_sp, B_b_sp, B_w_out, gate_w):

    def _A_ref(x, wqkv, wo):
        B, S, D = x.shape
        H = 32
        Dh = D // H
        qkv = (lambda x, *d: x.permute(*d))((x @ wqkv).reshape(B, S, 3, H, Dh), 2, 0, 3, 1, 4)
        q, k, v = (qkv[0], qkv[1], qkv[2])
        scores = torch.einsum('bhqd,bhkd->bhqk', q, k) * Dh ** (-0.5)
        p = _softmax(scores, axis=-1)
        o = torch.einsum('bhqk,bhkd->bhqd', p, v)
        return (lambda x, *d: x.permute(*d))(o, 0, 2, 1, 3).reshape(B, S, D) @ wo

    def _B_ref(x, w_in, w_sp, b_sp, w_out):
        B, S, D = x.shape
        F = w_in.shape[-1]
        Fh = F // 2
        z = _gelu(torch.einsum('bsd,df->bsf', x, w_in))
        z1 = z[..., :Fh].clone()
        z2 = _layernorm(z[..., Fh:], axis=-1)
        g = torch.einsum('ts,bsf->btf', w_sp, z2) + b_sp[None, :, None]
        return torch.einsum('bsf,fd->bsd', z1 * g, w_out)
    x = A_x
    g = _sigmoid((x * gate_w).sum(-1, keepdims=True))
    a = _A_ref(x, A_wqkv, A_wo)
    b = _B_ref(x, B_w_in, B_w_sp, B_b_sp, B_w_out)
    return g * a + (1 - g) * b
```

```asm
; @launch kernel=kf_kernel grid=(512,1,1) block=(512,1,1) lds=81920
.amdgcn_target "amdgcn-amd-amdhsa--gfx950"
.text
.globl kf_kernel
.p2align 8
.type kf_kernel,@function
kf_kernel:
    s_cmp_lt_u32 s2, 256
    s_cbranch_scc0 kf_g0
    s_load_dwordx2 s[20:21], s[0:1], 8
    s_load_dwordx2 s[16:17], s[0:1], 0
    v_lshrrev_b32 v4, 6, v0
    s_setprio 2
    s_cmp_lt_u32 s2, 8
    s_cbranch_scc0 kf_np
    s_getpc_b64 s[28:29]
kf_pc:
    s_mov_b32 s30, kf_end-kf_pc
    s_mov_b32 s31, 0x00020000
    v_lshlrev_b32 v127, 7, v0
    buffer_load_dword v127, v127, s[28:31], 0 offen
kf_np:
    v_readfirstlane_b32 s32, v4
    v_and_b32 v1, 63, v0
    s_and_b32 s33, s2, 7
    s_lshr_b32 s34, s2, 3
    v_lshrrev_b32 v5, 3, v1
    v_and_b32 v6, 7, v1
    s_and_b32 s75, s34, 7
    s_lshr_b32 s44, s34, 3
    v_bfe_u32 v7, v1, 4, 1
    v_mul_u32_u24 v8, 3072, v5
    s_and_b32 s57, s33, 1
    s_lshl_b32 s57, s57, 2
    v_lshlrev_b32 v7, 2, v7
    s_add_u32 s57, s57, s44
    s_lshl_b32 s44, s44, 1
    v_xor_b32 v7, v6, v7
    s_lshr_b32 s56, s33, 1
    s_lshl_b32 s56, s56, 3
    v_lshl_add_u32 v8, v7, 4, v8
    s_add_u32 s56, s56, s75
    s_add_u32 s75, s75, s44
    s_and_b32 s53, s75, 7
    s_lshl_b32 s45, s53, 3
    s_add_u32 s45, s45, s32
    s_mul_i32 s45, s45, 24576
    s_lshl_b32 s44, s57, 7
    s_add_u32 s45, s45, s44
    s_lshr_b32 s44, s32, 2
    s_mul_i32 s44, s44, 8192
    s_lshl_b32 s42, s32, 10
    s_add_u32 m0, s44, s42
    s_mov_b32 s22, 1572864
    s_mov_b32 s23, 0x00020000
    v_lshrrev_b32 v7, 4, v1
    s_waitcnt lgkmcnt(0)
    buffer_load_dwordx4 v8, s[20:23], s45 offen lds
    s_add_u32 m0, m0, 3072
    v_xor_b32 v6, v6, v7
    buffer_load_dwordx4 v8, s[20:23], s45 offen offset:1024 lds
    s_add_u32 m0, m0, 3072
    v_lshlrev_b32 v6, 4, v6
    buffer_load_dwordx4 v8, s[20:23], s45 offen offset:2048 lds
    s_lshl_b32 s44, s32, 6
    s_and_b32 s44, s44, 64
    v_lshl_add_u32 v6, v5, 10, v6
    s_lshl_b32 s45, s56, 3
    s_add_u32 s45, s45, s32
    v_xor_b32 v6, s44, v6
    s_lshl_b32 s45, s45, 13
    s_lshl_b32 s53, s53, 7
    s_add_u32 s45, s45, s53
    s_mov_b32 s18, 2097152
    s_add_u32 m0, s42, 49152
    s_mov_b32 s19, 0x00020000
    buffer_load_dwordx4 v6, s[16:19], s45 offen lds
    s_load_dwordx2 s[12:13], s[0:1], 88
    s_load_dwordx2 s[24:25], s[0:1], 80
    v_and_b32 v2, 31, v0
    v_bfe_u32 v3, v0, 5, 1
    s_mov_b32 s14, 268435456
    s_mov_b32 s15, 0x00020000
    s_mov_b32 s26, 256
    s_mov_b32 s27, 0x00020000
    s_cmp_eq_u32 s32, 7
    s_cbranch_scc1 kf_alx
    s_cmp_ge_u32 s32, 4
    s_cbranch_scc1 kf_alw
    s_branch kf_ac
kf_g0:
    s_load_dwordx2 s[16:17], s[0:1], 0
    s_load_dwordx2 s[12:13], s[0:1], 88
    v_lshrrev_b32 v4, 6, v0
    s_cmp_ge_u32 s2, 512
    s_cbranch_scc1 kf_exit
    v_readfirstlane_b32 s32, v4
    s_load_dwordx2 s[24:25], s[0:1], 80
    v_and_b32 v1, 63, v0
    v_and_b32 v2, 31, v0
    v_bfe_u32 v3, v0, 5, 1
    s_and_b32 s33, s2, 7
    s_lshr_b32 s60, s2, 3
    s_and_b32 s34, s60, 31
    s_mov_b32 s18, 2097152
    s_mov_b32 s19, 0x00020000
    s_mov_b32 s14, 268435456
    s_mov_b32 s15, 0x00020000
    s_mov_b32 s26, 256
    s_mov_b32 s27, 0x00020000
kf_g:
    s_load_dwordx2 s[20:21], s[0:1], 32
    s_load_dwordx2 s[8:9], s[0:1], 40
    s_load_dwordx2 s[68:69], s[0:1], 16
    s_load_dwordx2 s[64:65], s[0:1], 56
    s_load_dwordx2 s[4:5], s[0:1], 72
    s_mul_i32 s44, s34, 37
    s_lshr_b32 s44, s44, 8
    s_mul_i32 s45, s44, 7
    s_sub_u32 s35, s34, s45
    s_lshl_b32 s38, s33, 2
    s_add_u32 s38, s38, s44
    s_and_b32 s62, s38, 3
    s_mul_i32 s62, s62, 1
    s_lshl_b32 s74, s38, 1
    s_setprio 1
    s_lshr_b32 s56, s33, 1
    s_lshl_b32 s56, s56, 3
    s_and_b32 s45, s34, 7
    s_add_u32 s56, s56, s45
    s_lshr_b32 s44, s34, 3
    s_and_b32 s57, s33, 1
    s_lshl_b32 s57, s57, 2
    s_add_u32 s57, s57, s44
    s_lshl_b32 s75, s33, 2
    s_add_u32 s45, s45, s75
    s_cmp_lt_u32 s34, 24
    s_cselect_b32 s57, s57, 3
    s_cselect_b32 s56, s56, s45
    s_lshl_b32 s44, s44, 1
    s_add_u32 s75, s56, s44
    s_add_u32 s75, s75, 1
    s_mul_i32 s44, s34, 2
    s_mul_i32 s45, s33, 0
    s_add_u32 s44, s44, s45
    s_add_u32 s44, s44, 0
    s_cmp_lt_u32 s34, 24
    s_cselect_b32 s75, s75, s44
    s_mov_b32 s22, 1835008
    s_mov_b32 s23, 0x00020000
    s_mov_b32 s10, 8388608
    s_mov_b32 s11, 0x00020000
    s_mov_b32 s70, 524288
    s_mov_b32 s71, 0x00020000
    s_mov_b32 s66, 917504
    s_mov_b32 s67, 0x00020000
    s_mov_b32 s6, 2097152
    s_mov_b32 s7, 0x00020000
    s_cmp_ge_u32 s34, 28
    s_cbranch_scc1 kf_gate
    s_cmp_eq_u32 s32, 6
    s_cbranch_scc1 kf_glw
    s_cmp_eq_u32 s32, 7
    s_cbranch_scc1 kf_gh
    s_cmp_lt_u32 s32, 4
    s_cbranch_scc1 kf_gc
    s_sub_u32 s44, s32, 4
    s_lshl_b32 s42, s44, 13
    s_lshl_b32 s46, s44, 7
    s_lshl_b32 s45, s57, 8
    s_add_u32 s40, s46, s45
    s_add_u32 s40, s40, 1792
    s_lshl_b32 s45, s35, 8
    s_add_u32 s46, s46, s45
    v_lshrrev_b32 v5, 3, v1
    v_mul_u32_u24 v5, 3584, v5
    v_and_b32 v4, 7, v1
    v_bfe_u32 v6, v1, 4, 1
    v_lshlrev_b32 v6, 2, v6
    v_xor_b32 v4, v4, v6
    v_lshl_add_u32 v4, v4, 4, v5
    s_setprio 2
    s_waitcnt lgkmcnt(0)
    s_sleep 127
    s_sleep 13
    s_add_u32 s53, s75, 0
    s_and_b32 s53, s53, 7
    s_mul_i32 s45, s53, 229376
    s_add_u32 s45, s45, s40
    s_add_u32 m0, s42, 0
    s_add_u32 s41, s45, 0
    buffer_load_dwordx4 v4, s[20:23], s41 offen lds
    s_add_u32 m0, s42, 1024
    s_add_u32 s41, s45, 28672
    buffer_load_dwordx4 v4, s[20:23], s41 offen lds
    s_add_u32 m0, s42, 2048
    s_add_u32 s41, s45, 57344
    buffer_load_dwordx4 v4, s[20:23], s41 offen lds
    s_add_u32 m0, s42, 3072
    s_add_u32 s41, s45, 86016
    buffer_load_dwordx4 v4, s[20:23], s41 offen lds
    s_add_u32 m0, s42, 4096
    s_add_u32 s41, s45, 114688
    buffer_load_dwordx4 v4, s[20:23], s41 offen lds
    s_add_u32 m0, s42, 5120
    s_add_u32 s41, s45, 143360
    buffer_load_dwordx4 v4, s[20:23], s41 offen lds
    s_add_u32 m0, s42, 6144
    s_add_u32 s41, s45, 172032
    buffer_load_dwordx4 v4, s[20:23], s41 offen lds
    s_add_u32 m0, s42, 7168
    s_add_u32 s41, s45, 200704
    buffer_load_dwordx4 v4, s[20:23], s41 offen lds
    s_add_u32 s53, s75, 1
    s_and_b32 s53, s53, 7
    s_mul_i32 s45, s53, 229376
    s_add_u32 s45, s45, s40
    s_add_u32 m0, s42, 24576
    s_add_u32 s41, s45, 0
    buffer_load_dwordx4 v4, s[20:23], s41 offen lds
    s_add_u32 m0, s42, 25600
    s_add_u32 s41, s45, 28672
    buffer_load_dwordx4 v4, s[20:23], s41 offen lds
    s_add_u32 m0, s42, 26624
    s_add_u32 s41, s45, 57344
    buffer_load_dwordx4 v4, s[20:23], s41 offen lds
    s_add_u32 m0, s42, 27648
    s_add_u32 s41, s45, 86016
    buffer_load_dwordx4 v4, s[20:23], s41 offen lds
    s_add_u32 m0, s42, 28672
    s_add_u32 s41, s45, 114688
    buffer_load_dwordx4 v4, s[20:23], s41 offen lds
    s_add_u32 m0, s42, 29696
    s_add_u32 s41, s45, 143360
    buffer_load_dwordx4 v4, s[20:23], s41 offen lds
    s_add_u32 m0, s42, 30720
    s_add_u32 s41, s45, 172032
    buffer_load_dwordx4 v4, s[20:23], s41 offen lds
    s_add_u32 m0, s42, 31744
    s_add_u32 s41, s45, 200704
    buffer_load_dwordx4 v4, s[20:23], s41 offen lds
    s_add_u32 s53, s75, 2
    s_and_b32 s53, s53, 7
    s_mul_i32 s45, s53, 229376
    s_add_u32 s45, s45, s40
    s_add_u32 m0, s42, 49152
    s_add_u32 s41, s45, 0
    buffer_load_dwordx4 v4, s[20:23], s41 offen lds
    s_add_u32 m0, s42, 50176
    s_add_u32 s41, s45, 28672
    buffer_load_dwordx4 v4, s[20:23], s41 offen lds
    s_add_u32 m0, s42, 51200
    s_add_u32 s41, s45, 57344
    buffer_load_dwordx4 v4, s[20:23], s41 offen lds
    s_add_u32 m0, s42, 52224
    s_add_u32 s41, s45, 86016
    buffer_load_dwordx4 v4, s[20:23], s41 offen lds
    s_add_u32 m0, s42, 53248
    s_add_u32 s41, s45, 114688
    buffer_load_dwordx4 v4, s[20:23], s41 offen lds
    s_add_u32 m0, s42, 54272
    s_add_u32 s41, s45, 143360
    buffer_load_dwordx4 v4, s[20:23], s41 offen lds
    s_add_u32 m0, s42, 55296
    s_add_u32 s41, s45, 172032
    buffer_load_dwordx4 v4, s[20:23], s41 offen lds
    s_add_u32 m0, s42, 56320
    s_add_u32 s41, s45, 200704
    buffer_load_dwordx4 v4, s[20:23], s41 offen lds
    s_waitcnt vmcnt(16)
    s_barrier
    s_waitcnt vmcnt(8)
    s_barrier
    s_add_u32 s53, s75, 3
    s_and_b32 s53, s53, 7
    s_mul_i32 s45, s53, 229376
    s_add_u32 s45, s45, s40
    s_add_u32 m0, s42, 0
    s_add_u32 s41, s45, 0
    buffer_load_dwordx4 v4, s[20:23], s41 offen lds
    s_add_u32 m0, s42, 1024
    s_add_u32 s41, s45, 28672
    buffer_load_dwordx4 v4, s[20:23], s41 offen lds
    s_add_u32 m0, s42, 2048
    s_add_u32 s41, s45, 57344
    buffer_load_dwordx4 v4, s[20:23], s41 offen lds
    s_add_u32 m0, s42, 3072
    s_add_u32 s41, s45, 86016
    buffer_load_dwordx4 v4, s[20:23], s41 offen lds
    s_add_u32 m0, s42, 4096
    s_add_u32 s41, s45, 114688
    buffer_load_dwordx4 v4, s[20:23], s41 offen lds
    s_add_u32 m0, s42, 5120
    s_add_u32 s41, s45, 143360
    buffer_load_dwordx4 v4, s[20:23], s41 offen lds
    s_add_u32 m0, s42, 6144
    s_add_u32 s41, s45, 172032
    buffer_load_dwordx4 v4, s[20:23], s41 offen lds
    s_add_u32 m0, s42, 7168
    s_add_u32 s41, s45, 200704
    buffer_load_dwordx4 v4, s[20:23], s41 offen lds
    s_waitcnt vmcnt(8)
    s_barrier
    s_add_u32 s53, s75, 4
    s_and_b32 s53, s53, 7
    s_mul_i32 s45, s53, 229376
    s_add_u32 s45, s45, s40
    s_add_u32 m0, s42, 24576
    s_add_u32 s41, s45, 0
    buffer_load_dwordx4 v4, s[20:23], s41 offen lds
    s_add_u32 m0, s42, 25600
    s_add_u32 s41, s45, 28672
    buffer_load_dwordx4 v4, s[20:23], s41 offen lds
    s_add_u32 m0, s42, 26624
    s_add_u32 s41, s45, 57344
    buffer_load_dwordx4 v4, s[20:23], s41 offen lds
    s_add_u32 m0, s42, 27648
    s_add_u32 s41, s45, 86016
    buffer_load_dwordx4 v4, s[20:23], s41 offen lds
    s_add_u32 m0, s42, 28672
    s_add_u32 s41, s45, 114688
    buffer_load_dwordx4 v4, s[20:23], s41 offen lds
    s_add_u32 m0, s42, 29696
    s_add_u32 s41, s45, 143360
    buffer_load_dwordx4 v4, s[20:23], s41 offen lds
    s_add_u32 m0, s42, 30720
    s_add_u32 s41, s45, 172032
    buffer_load_dwordx4 v4, s[20:23], s41 offen lds
    s_add_u32 m0, s42, 31744
    s_add_u32 s41, s45, 200704
    buffer_load_dwordx4 v4, s[20:23], s41 offen lds
    s_waitcnt vmcnt(8)
    s_barrier
    s_add_u32 s53, s75, 5
    s_and_b32 s53, s53, 7
    s_mul_i32 s45, s53, 229376
    s_add_u32 s45, s45, s40
    s_add_u32 m0, s42, 49152
    s_add_u32 s41, s45, 0
    buffer_load_dwordx4 v4, s[20:23], s41 offen lds
    s_add_u32 m0, s42, 50176
    s_add_u32 s41, s45, 28672
    buffer_load_dwordx4 v4, s[20:23], s41 offen lds
    s_add_u32 m0, s42, 51200
    s_add_u32 s41, s45, 57344
    buffer_load_dwordx4 v4, s[20:23], s41 offen lds
    s_add_u32 m0, s42, 52224
    s_add_u32 s41, s45, 86016
    buffer_load_dwordx4 v4, s[20:23], s41 offen lds
    s_add_u32 m0, s42, 53248
    s_add_u32 s41, s45, 114688
    buffer_load_dwordx4 v4, s[20:23], s41 offen lds
    s_add_u32 m0, s42, 54272
    s_add_u32 s41, s45, 143360
    buffer_load_dwordx4 v4, s[20:23], s41 offen lds
    s_add_u32 m0, s42, 55296
    s_add_u32 s41, s45, 172032
    buffer_load_dwordx4 v4, s[20:23], s41 offen lds
    s_add_u32 m0, s42, 56320
    s_add_u32 s41, s45, 200704
    buffer_load_dwordx4 v4, s[20:23], s41 offen lds
    s_waitcnt vmcnt(8)
    s_barrier
    s_add_u32 s53, s75, 6
    s_and_b32 s53, s53, 7
    s_mul_i32 s45, s53, 229376
    s_add_u32 s45, s45, s40
    s_add_u32 m0, s42, 0
    s_add_u32 s41, s45, 0
    buffer_load_dwordx4 v4, s[20:23], s41 offen lds
    s_add_u32 m0, s42, 1024
    s_add_u32 s41, s45, 28672
    buffer_load_dwordx4 v4, s[20:23], s41 offen lds
    s_add_u32 m0, s42, 2048
    s_add_u32 s41, s45, 57344
    buffer_load_dwordx4 v4, s[20:23], s41 offen lds
    s_add_u32 m0, s42, 3072
    s_add_u32 s41, s45, 86016
    buffer_load_dwordx4 v4, s[20:23], s41 offen lds
    s_add_u32 m0, s42, 4096
    s_add_u32 s41, s45, 114688
    buffer_load_dwordx4 v4, s[20:23], s41 offen lds
    s_add_u32 m0, s42, 5120
    s_add_u32 s41, s45, 143360
    buffer_load_dwordx4 v4, s[20:23], s41 offen lds
    s_add_u32 m0, s42, 6144
    s_add_u32 s41, s45, 172032
    buffer_load_dwordx4 v4, s[20:23], s41 offen lds
    s_add_u32 m0, s42, 7168
    s_add_u32 s41, s45, 200704
    buffer_load_dwordx4 v4, s[20:23], s41 offen lds
    s_waitcnt vmcnt(8)
    s_barrier
    s_add_u32 s53, s75, 7
    s_and_b32 s53, s53, 7
    s_mul_i32 s45, s53, 229376
    s_add_u32 s45, s45, s40
    s_add_u32 m0, s42, 24576
    s_add_u32 s41, s45, 0
    buffer_load_dwordx4 v4, s[20:23], s41 offen lds
    s_add_u32 m0, s42, 25600
    s_add_u32 s41, s45, 28672
    buffer_load_dwordx4 v4, s[20:23], s41 offen lds
    s_add_u32 m0, s42, 26624
    s_add_u32 s41, s45, 57344
    buffer_load_dwordx4 v4, s[20:23], s41 offen lds
    s_add_u32 m0, s42, 27648
    s_add_u32 s41, s45, 86016
    buffer_load_dwordx4 v4, s[20:23], s41 offen lds
    s_add_u32 m0, s42, 28672
    s_add_u32 s41, s45, 114688
    buffer_load_dwordx4 v4, s[20:23], s41 offen lds
    s_add_u32 m0, s42, 29696
    s_add_u32 s41, s45, 143360
    buffer_load_dwordx4 v4, s[20:23], s41 offen lds
    s_add_u32 m0, s42, 30720
    s_add_u32 s41, s45, 172032
    buffer_load_dwordx4 v4, s[20:23], s41 offen lds
    s_add_u32 m0, s42, 31744
    s_add_u32 s41, s45, 200704
    buffer_load_dwordx4 v4, s[20:23], s41 offen lds
    s_waitcnt vmcnt(8)
    s_barrier
    s_setprio 0
    s_add_u32 s53, s74, 0
    s_and_b32 s53, s53, 7
    s_mul_i32 s45, s53, 229376
    s_add_u32 s45, s45, s46
    s_add_u32 m0, s42, 49152
    s_add_u32 s41, s45, 0
    buffer_load_dwordx4 v4, s[20:23], s41 offen lds
    s_add_u32 m0, s42, 50176
    s_add_u32 s41, s45, 28672
    buffer_load_dwordx4 v4, s[20:23], s41 offen lds
    s_add_u32 m0, s42, 51200
    s_add_u32 s41, s45, 57344
    buffer_load_dwordx4 v4, s[20:23], s41 offen lds
    s_add_u32 m0, s42, 52224
    s_add_u32 s41, s45, 86016
    buffer_load_dwordx4 v4, s[20:23], s41 offen lds
    s_add_u32 m0, s42, 53248
    s_add_u32 s41, s45, 114688
    buffer_load_dwordx4 v4, s[20:23], s41 offen lds
    s_add_u32 m0, s42, 54272
    s_add_u32 s41, s45, 143360
    buffer_load_dwordx4 v4, s[20:23], s41 offen lds
    s_add_u32 m0, s42, 55296
    s_add_u32 s41, s45, 172032
    buffer_load_dwordx4 v4, s[20:23], s41 offen lds
    s_add_u32 m0, s42, 56320
    s_add_u32 s41, s45, 200704
    buffer_load_dwordx4 v4, s[20:23], s41 offen lds
    s_waitcnt vmcnt(8)
    s_barrier
    s_add_u32 s53, s74, 1
    s_and_b32 s53, s53, 7
    s_mul_i32 s45, s53, 229376
    s_add_u32 s45, s45, s46
    s_add_u32 m0, s42, 0
    s_add_u32 s41, s45, 0
    buffer_load_dwordx4 v4, s[20:23], s41 offen lds
    s_add_u32 m0, s42, 1024
    s_add_u32 s41, s45, 28672
    buffer_load_dwordx4 v4, s[20:23], s41 offen lds
    s_add_u32 m0, s42, 2048
    s_add_u32 s41, s45, 57344
    buffer_load_dwordx4 v4, s[20:23], s41 offen lds
    s_add_u32 m0, s42, 3072
    s_add_u32 s41, s45, 86016
    buffer_load_dwordx4 v4, s[20:23], s41 offen lds
    s_add_u32 m0, s42, 4096
    s_add_u32 s41, s45, 114688
    buffer_load_dwordx4 v4, s[20:23], s41 offen lds
    s_add_u32 m0, s42, 5120
    s_add_u32 s41, s45, 143360
    buffer_load_dwordx4 v4, s[20:23], s41 offen lds
    s_add_u32 m0, s42, 6144
    s_add_u32 s41, s45, 172032
    buffer_load_dwordx4 v4, s[20:23], s41 offen lds
    s_add_u32 m0, s42, 7168
    s_add_u32 s41, s45, 200704
    buffer_load_dwordx4 v4, s[20:23], s41 offen lds
    s_waitcnt vmcnt(8)
    s_barrier
    s_add_u32 s53, s74, 2
    s_and_b32 s53, s53, 7
    s_mul_i32 s45, s53, 229376
    s_add_u32 s45, s45, s46
    s_add_u32 m0, s42, 24576
    s_add_u32 s41, s45, 0
    buffer_load_dwordx4 v4, s[20:23], s41 offen lds
    s_add_u32 m0, s42, 25600
    s_add_u32 s41, s45, 28672
    buffer_load_dwordx4 v4, s[20:23], s41 offen lds
    s_add_u32 m0, s42, 26624
    s_add_u32 s41, s45, 57344
    buffer_load_dwordx4 v4, s[20:23], s41 offen lds
    s_add_u32 m0, s42, 27648
    s_add_u32 s41, s45, 86016
    buffer_load_dwordx4 v4, s[20:23], s41 offen lds
    s_add_u32 m0, s42, 28672
    s_add_u32 s41, s45, 114688
    buffer_load_dwordx4 v4, s[20:23], s41 offen lds
    s_add_u32 m0, s42, 29696
    s_add_u32 s41, s45, 143360
    buffer_load_dwordx4 v4, s[20:23], s41 offen lds
    s_add_u32 m0, s42, 30720
    s_add_u32 s41, s45, 172032
    buffer_load_dwordx4 v4, s[20:23], s41 offen lds
    s_add_u32 m0, s42, 31744
    s_add_u32 s41, s45, 200704
    buffer_load_dwordx4 v4, s[20:23], s41 offen lds
    s_waitcnt vmcnt(8)
    s_barrier
    s_add_u32 s53, s74, 3
    s_and_b32 s53, s53, 7
    s_mul_i32 s45, s53, 229376
    s_add_u32 s45, s45, s46
    s_add_u32 m0, s42, 49152
    s_add_u32 s41, s45, 0
    buffer_load_dwordx4 v4, s[20:23], s41 offen lds
    s_add_u32 m0, s42, 50176
    s_add_u32 s41, s45, 28672
    buffer_load_dwordx4 v4, s[20:23], s41 offen lds
    s_add_u32 m0, s42, 51200
    s_add_u32 s41, s45, 57344
    buffer_load_dwordx4 v4, s[20:23], s41 offen lds
    s_add_u32 m0, s42, 52224
    s_add_u32 s41, s45, 86016
    buffer_load_dwordx4 v4, s[20:23], s41 offen lds
    s_add_u32 m0, s42, 53248
    s_add_u32 s41, s45, 114688
    buffer_load_dwordx4 v4, s[20:23], s41 offen lds
    s_add_u32 m0, s42, 54272
    s_add_u32 s41, s45, 143360
    buffer_load_dwordx4 v4, s[20:23], s41 offen lds
    s_add_u32 m0, s42, 55296
    s_add_u32 s41, s45, 172032
    buffer_load_dwordx4 v4, s[20:23], s41 offen lds
    s_add_u32 m0, s42, 56320
    s_add_u32 s41, s45, 200704
    buffer_load_dwordx4 v4, s[20:23], s41 offen lds
    s_waitcnt vmcnt(8)
    s_barrier
    s_add_u32 s53, s74, 4
    s_and_b32 s53, s53, 7
    s_mul_i32 s45, s53, 229376
    s_add_u32 s45, s45, s46
    s_add_u32 m0, s42, 0
    s_add_u32 s41, s45, 0
    buffer_load_dwordx4 v4, s[20:23], s41 offen lds
    s_add_u32 m0, s42, 1024
    s_add_u32 s41, s45, 28672
    buffer_load_dwordx4 v4, s[20:23], s41 offen lds
    s_add_u32 m0, s42, 2048
    s_add_u32 s41, s45, 57344
    buffer_load_dwordx4 v4, s[20:23], s41 offen lds
    s_add_u32 m0, s42, 3072
    s_add_u32 s41, s45, 86016
    buffer_load_dwordx4 v4, s[20:23], s41 offen lds
    s_add_u32 m0, s42, 4096
    s_add_u32 s41, s45, 114688
    buffer_load_dwordx4 v4, s[20:23], s41 offen lds
    s_add_u32 m0, s42, 5120
    s_add_u32 s41, s45, 143360
    buffer_load_dwordx4 v4, s[20:23], s41 offen lds
    s_add_u32 m0, s42, 6144
    s_add_u32 s41, s45, 172032
    buffer_load_dwordx4 v4, s[20:23], s41 offen lds
    s_add_u32 m0, s42, 7168
    s_add_u32 s41, s45, 200704
    buffer_load_dwordx4 v4, s[20:23], s41 offen lds
    s_waitcnt vmcnt(8)
    s_barrier
    s_add_u32 s53, s74, 5
    s_and_b32 s53, s53, 7
    s_mul_i32 s45, s53, 229376
    s_add_u32 s45, s45, s46
    s_add_u32 m0, s42, 24576
    s_add_u32 s41, s45, 0
    buffer_load_dwordx4 v4, s[20:23], s41 offen lds
    s_add_u32 m0, s42, 25600
    s_add_u32 s41, s45, 28672
    buffer_load_dwordx4 v4, s[20:23], s41 offen lds
    s_add_u32 m0, s42, 26624
    s_add_u32 s41, s45, 57344
    buffer_load_dwordx4 v4, s[20:23], s41 offen lds
    s_add_u32 m0, s42, 27648
    s_add_u32 s41, s45, 86016
    buffer_load_dwordx4 v4, s[20:23], s41 offen lds
    s_add_u32 m0, s42, 28672
    s_add_u32 s41, s45, 114688
    buffer_load_dwordx4 v4, s[20:23], s41 offen lds
    s_add_u32 m0, s42, 29696
    s_add_u32 s41, s45, 143360
    buffer_load_dwordx4 v4, s[20:23], s41 offen lds
    s_add_u32 m0, s42, 30720
    s_add_u32 s41, s45, 172032
    buffer_load_dwordx4 v4, s[20:23], s41 offen lds
    s_add_u32 m0, s42, 31744
    s_add_u32 s41, s45, 200704
    buffer_load_dwordx4 v4, s[20:23], s41 offen lds
    s_waitcnt vmcnt(8)
    s_barrier
    s_add_u32 s53, s74, 6
    s_and_b32 s53, s53, 7
    s_mul_i32 s45, s53, 229376
    s_add_u32 s45, s45, s46
    s_add_u32 m0, s42, 49152
    s_add_u32 s41, s45, 0
    buffer_load_dwordx4 v4, s[20:23], s41 offen lds
    s_add_u32 m0, s42, 50176
    s_add_u32 s41, s45, 28672
    buffer_load_dwordx4 v4, s[20:23], s41 offen lds
    s_add_u32 m0, s42, 51200
    s_add_u32 s41, s45, 57344
    buffer_load_dwordx4 v4, s[20:23], s41 offen lds
    s_add_u32 m0, s42, 52224
    s_add_u32 s41, s45, 86016
    buffer_load_dwordx4 v4, s[20:23], s41 offen lds
    s_add_u32 m0, s42, 53248
    s_add_u32 s41, s45, 114688
    buffer_load_dwordx4 v4, s[20:23], s41 offen lds
    s_add_u32 m0, s42, 54272
    s_add_u32 s41, s45, 143360
    buffer_load_dwordx4 v4, s[20:23], s41 offen lds
    s_add_u32 m0, s42, 55296
    s_add_u32 s41, s45, 172032
    buffer_load_dwordx4 v4, s[20:23], s41 offen lds
    s_add_u32 m0, s42, 56320
    s_add_u32 s41, s45, 200704
    buffer_load_dwordx4 v4, s[20:23], s41 offen lds
    s_waitcnt vmcnt(8)
    s_barrier
    s_add_u32 s53, s74, 7
    s_and_b32 s53, s53, 7
    s_mul_i32 s45, s53, 229376
    s_add_u32 s45, s45, s46
    s_add_u32 m0, s42, 0
    s_add_u32 s41, s45, 0
    buffer_load_dwordx4 v4, s[20:23], s41 offen lds
    s_add_u32 m0, s42, 1024
    s_add_u32 s41, s45, 28672
    buffer_load_dwordx4 v4, s[20:23], s41 offen lds
    s_add_u32 m0, s42, 2048
    s_add_u32 s41, s45, 57344
    buffer_load_dwordx4 v4, s[20:23], s41 offen lds
    s_add_u32 m0, s42, 3072
    s_add_u32 s41, s45, 86016
    buffer_load_dwordx4 v4, s[20:23], s41 offen lds
    s_add_u32 m0, s42, 4096
    s_add_u32 s41, s45, 114688
    buffer_load_dwordx4 v4, s[20:23], s41 offen lds
    s_add_u32 m0, s42, 5120
    s_add_u32 s41, s45, 143360
    buffer_load_dwordx4 v4, s[20:23], s41 offen lds
    s_add_u32 m0, s42, 6144
    s_add_u32 s41, s45, 172032
    buffer_load_dwordx4 v4, s[20:23], s41 offen lds
    s_add_u32 m0, s42, 7168
    s_add_u32 s41, s45, 200704
    buffer_load_dwordx4 v4, s[20:23], s41 offen lds
    s_waitcnt vmcnt(8)
    s_barrier
    s_waitcnt vmcnt(0)
    s_barrier
    s_mul_i32 s36, s38, 8320
    s_lshl_b32 s37, s35, 7
    s_add_u32 s36, s36, s37
    s_add_u32 s36, s36, 19404800
    s_mov_b32 s49, s36
    s_lshl_b32 s37, s62, 2
    s_add_u32 s36, s36, s37
    s_add_u32 s36, s36, s12
    s_addc_u32 s37, s13, 0
    s_load_dwordx8 s[24:31], s[36:37], 0 glc
    s_setprio 2
    s_lshl_b32 s44, s44, 1
    s_lshl_b32 s45, s35, 2
    s_add_u32 s44, s44, s45
    s_lshl_b32 s40, s44, 17
    s_add_u32 s40, s40, 14680064
    s_add_u32 s47, s40, 131072
    v_lshlrev_b32 v9, 4, v1
    s_lshl_b32 s43, s62, 12
    s_mov_b32 s53, 0
kf_lp:
    s_waitcnt lgkmcnt(0)
    s_or_b64 s[24:25], s[24:25], s[26:27]
    s_or_b64 s[24:25], s[24:25], s[28:29]
    s_or_b64 s[24:25], s[24:25], s[30:31]
    s_or_b32 s24, s24, s25
    s_cmp_eq_u32 s24, 1
    s_cbranch_scc1 kf_lpf_done
    s_sleep 2
    s_load_dwordx8 s[24:31], s[36:37], 0 glc
    s_add_u32 s53, s53, 1
    s_cmp_lt_u32 s53, 400
    s_cbranch_scc1 kf_lp
    v_lshlrev_b32 v14, 2, v2
    s_mov_b64 exec, 0xffffffff
    s_mov_b32 s53, 0
kf_lpf:
    buffer_load_dword v10, v14, s[12:15], s49 offen sc1
    s_add_u32 s53, s53, 1
    s_waitcnt vmcnt(0)
    v_cmp_ne_u32 vcc, 1, v10
    s_cbranch_vccz kf_lpf_done
    s_sleep 8
    s_cmp_lt_u32 s53, 131072
    s_cbranch_scc1 kf_lpf
kf_lpf_done:
    s_mov_b64 exec, -1
    s_add_u32 m0, s42, 24576
    s_add_u32 s45, s40, s43
    buffer_load_dwordx4 v9, s[12:15], s45 offen offset:0 sc1 lds
    buffer_load_dwordx4 v9, s[12:15], s45 offen offset:1024 sc1 lds
    buffer_load_dwordx4 v9, s[12:15], s45 offen offset:2048 sc1 lds
    buffer_load_dwordx4 v9, s[12:15], s45 offen offset:3072 sc1 lds
    s_add_u32 m0, s42, 28672
    s_add_u32 s45, s47, s43
    buffer_load_dwordx4 v9, s[12:15], s45 offen offset:0 sc1 lds
    buffer_load_dwordx4 v9, s[12:15], s45 offen offset:1024 sc1 lds
    buffer_load_dwordx4 v9, s[12:15], s45 offen offset:2048 sc1 lds
    buffer_load_dwordx4 v9, s[12:15], s45 offen offset:3072 sc1 lds
    s_add_u32 s43, s43, 4096
    s_and_b32 s43, s43, 0x1ffff
    s_add_u32 m0, s42, 49152
    s_add_u32 s45, s40, s43
    buffer_load_dwordx4 v9, s[12:15], s45 offen offset:0 sc1 lds
    buffer_load_dwordx4 v9, s[12:15], s45 offen offset:1024 sc1 lds
    buffer_load_dwordx4 v9, s[12:15], s45 offen offset:2048 sc1 lds
    buffer_load_dwordx4 v9, s[12:15], s45 offen offset:3072 sc1 lds
    s_add_u32 m0, s42, 53248
    s_add_u32 s45, s47, s43
    buffer_load_dwordx4 v9, s[12:15], s45 offen offset:0 sc1 lds
    buffer_load_dwordx4 v9, s[12:15], s45 offen offset:1024 sc1 lds
    buffer_load_dwordx4 v9, s[12:15], s45 offen offset:2048 sc1 lds
    buffer_load_dwordx4 v9, s[12:15], s45 offen offset:3072 sc1 lds
    s_add_u32 s43, s43, 4096
    s_and_b32 s43, s43, 0x1ffff
    s_mov_b32 s54, 0
kf_lz:
    s_waitcnt vmcnt(8)
    s_barrier
    s_add_u32 m0, s42, 0
    s_add_u32 s45, s40, s43
    buffer_load_dwordx4 v9, s[12:15], s45 offen offset:0 sc1 lds
    buffer_load_dwordx4 v9, s[12:15], s45 offen offset:1024 sc1 lds
    buffer_load_dwordx4 v9, s[12:15], s45 offen offset:2048 sc1 lds
    buffer_load_dwordx4 v9, s[12:15], s45 offen offset:3072 sc1 lds
    s_add_u32 m0, s42, 4096
    s_add_u32 s45, s47, s43
    buffer_load_dwordx4 v9, s[12:15], s45 offen offset:0 sc1 lds
    buffer_load_dwordx4 v9, s[12:15], s45 offen offset:1024 sc1 lds
    buffer_load_dwordx4 v9, s[12:15], s45 offen offset:2048 sc1 lds
    buffer_load_dwordx4 v9, s[12:15], s45 offen offset:3072 sc1 lds
    s_add_u32 s43, s43, 4096
    s_and_b32 s43, s43, 0x1ffff
    s_waitcnt vmcnt(8)
    s_barrier
    s_add_u32 m0, s42, 24576
    s_add_u32 s45, s40, s43
    buffer_load_dwordx4 v9, s[12:15], s45 offen offset:0 sc1 lds
    buffer_load_dwordx4 v9, s[12:15], s45 offen offset:1024 sc1 lds
    buffer_load_dwordx4 v9, s[12:15], s45 offen offset:2048 sc1 lds
    buffer_load_dwordx4 v9, s[12:15], s45 offen offset:3072 sc1 lds
    s_add_u32 m0, s42, 28672
    s_add_u32 s45, s47, s43
    buffer_load_dwordx4 v9, s[12:15], s45 offen offset:0 sc1 lds
    buffer_load_dwordx4 v9, s[12:15], s45 offen offset:1024 sc1 lds
    buffer_load_dwordx4 v9, s[12:15], s45 offen offset:2048 sc1 lds
    buffer_load_dwordx4 v9, s[12:15], s45 offen offset:3072 sc1 lds
    s_add_u32 s43, s43, 4096
    s_and_b32 s43, s43, 0x1ffff
    s_waitcnt vmcnt(8)
    s_barrier
    s_add_u32 m0, s42, 49152
    s_add_u32 s45, s40, s43
    buffer_load_dwordx4 v9, s[12:15], s45 offen offset:0 sc1 lds
    buffer_load_dwordx4 v9, s[12:15], s45 offen offset:1024 sc1 lds
    buffer_load_dwordx4 v9, s[12:15], s45 offen offset:2048 sc1 lds
    buffer_load_dwordx4 v9, s[12:15], s45 offen offset:3072 sc1 lds
    s_add_u32 m0, s42, 53248
    s_add_u32 s45, s47, s43
    buffer_load_dwordx4 v9, s[12:15], s45 offen offset:0 sc1 lds
    buffer_load_dwordx4 v9, s[12:15], s45 offen offset:1024 sc1 lds
    buffer_load_dwordx4 v9, s[12:15], s45 offen offset:2048 sc1 lds
    buffer_load_dwordx4 v9, s[12:15], s45 offen offset:3072 sc1 lds
    s_add_u32 s43, s43, 4096
    s_and_b32 s43, s43, 0x1ffff
    s_add_u32 s54, s54, 1
    s_cmp_lt_u32 s54, 10
    s_cbranch_scc1 kf_lz
    s_branch k2_pre
kf_glw:
    s_lshl_b32 s46, s56, 16
    s_lshl_b32 s47, s38, 16
    v_lshrrev_b32 v13, 3, v1
    v_and_b32 v6, 7, v1
    v_lshrrev_b32 v14, 4, v1
    v_xor_b32 v6, v6, v14
    v_lshlrev_b32 v6, 4, v6
    v_lshl_add_u32 v6, v13, 10, v6
    v_xor_b32 v7, 64, v6
    s_setprio 2
    s_waitcnt lgkmcnt(0)
    s_sleep 127
    s_sleep 13
    s_add_u32 s53, s75, 0
    s_and_b32 s53, s53, 7
    s_mul_i32 s45, s53, 128
    s_add_u32 s45, s45, s46
    s_mov_b32 m0, 16384
    s_add_u32 s41, s45, 0
    buffer_load_dwordx4 v6, s[16:19], s41 offen lds
    s_mov_b32 m0, 17408
    s_add_u32 s41, s45, 8192
    buffer_load_dwordx4 v7, s[16:19], s41 offen lds
    s_mov_b32 m0, 18432
    s_add_u32 s41, s45, 16384
    buffer_load_dwordx4 v6, s[16:19], s41 offen lds
    s_mov_b32 m0, 19456
    s_add_u32 s41, s45, 24576
    buffer_load_dwordx4 v7, s[16:19], s41 offen lds
    s_mov_b32 m0, 20480
    s_add_u32 s41, s45, 32768
    buffer_load_dwordx4 v6, s[16:19], s41 offen lds
    s_mov_b32 m0, 21504
    s_add_u32 s41, s45, 40960
    buffer_load_dwordx4 v7, s[16:19], s41 offen lds
    s_mov_b32 m0, 22528
    s_add_u32 s41, s45, 49152
    buffer_load_dwordx4 v6, s[16:19], s41 offen lds
    s_mov_b32 m0, 23552
    s_add_u32 s41, s45, 57344
    buffer_load_dwordx4 v7, s[16:19], s41 offen lds
    s_add_u32 s53, s75, 1
    s_and_b32 s53, s53, 7
    s_mul_i32 s45, s53, 128
    s_add_u32 s45, s45, s46
    s_mov_b32 m0, 40960
    s_add_u32 s41, s45, 0
    buffer_load_dwordx4 v6, s[16:19], s41 offen lds
    s_mov_b32 m0, 41984
    s_add_u32 s41, s45, 8192
    buffer_load_dwordx4 v7, s[16:19], s41 offen lds
    s_mov_b32 m0, 43008
    s_add_u32 s41, s45, 16384
    buffer_load_dwordx4 v6, s[16:19], s41 offen lds
    s_mov_b32 m0, 44032
    s_add_u32 s41, s45, 24576
    buffer_load_dwordx4 v7, s[16:19], s41 offen lds
    s_mov_b32 m0, 45056
    s_add_u32 s41, s45, 32768
    buffer_load_dwordx4 v6, s[16:19], s41 offen lds
    s_mov_b32 m0, 46080
    s_add_u32 s41, s45, 40960
    buffer_load_dwordx4 v7, s[16:19], s41 offen lds
    s_mov_b32 m0, 47104
    s_add_u32 s41, s45, 49152
    buffer_load_dwordx4 v6, s[16:19], s41 offen lds
    s_mov_b32 m0, 48128
    s_add_u32 s41, s45, 57344
    buffer_load_dwordx4 v7, s[16:19], s41 offen lds
    s_add_u32 s53, s75, 2
    s_and_b32 s53, s53, 7
    s_mul_i32 s45, s53, 128
    s_add_u32 s45, s45, s46
    s_mov_b32 m0, 65536
    s_add_u32 s41, s45, 0
    buffer_load_dwordx4 v6, s[16:19], s41 offen lds
    s_mov_b32 m0, 66560
    s_add_u32 s41, s45, 8192
    buffer_load_dwordx4 v7, s[16:19], s41 offen lds
    s_mov_b32 m0, 67584
    s_add_u32 s41, s45, 16384
    buffer_load_dwordx4 v6, s[16:19], s41 offen lds
    s_mov_b32 m0, 68608
    s_add_u32 s41, s45, 24576
    buffer_load_dwordx4 v7, s[16:19], s41 offen lds
    s_mov_b32 m0, 69632
    s_add_u32 s41, s45, 32768
    buffer_load_dwordx4 v6, s[16:19], s41 offen lds
    s_mov_b32 m0, 70656
    s_add_u32 s41, s45, 40960
    buffer_load_dwordx4 v7, s[16:19], s41 offen lds
    s_mov_b32 m0, 71680
    s_add_u32 s41, s45, 49152
    buffer_load_dwordx4 v6, s[16:19], s41 offen lds
    s_mov_b32 m0, 72704
    s_add_u32 s41, s45, 57344
    buffer_load_dwordx4 v7, s[16:19], s41 offen lds
    v_lshrrev_b32 v13, 3, v1
    v_and_b32 v4, 7, v1
    v_lshrrev_b32 v14, 4, v1
    v_xor_b32 v4, v4, v14
    v_lshlrev_b32 v4, 4, v4
    v_lshl_add_u32 v4, v13, 12, v4
    v_xor_b32 v5, 64, v4
    v_add_u32 v5, 31744, v5
    s_lshl_b32 s42, s38, 18
    s_add_u32 s43, s62, 0
    s_and_b32 s43, s43, 31
    s_lshl_b32 s43, s43, 7
    s_add_u32 s40, s42, s43
    s_waitcnt vmcnt(16)
    s_barrier
    s_waitcnt vmcnt(8)
    s_barrier
    s_add_u32 s53, s75, 3
    s_and_b32 s53, s53, 7
    s_mul_i32 s45, s53, 128
    s_add_u32 s45, s45, s46
    s_mov_b32 m0, 16384
    s_add_u32 s41, s45, 0
    buffer_load_dwordx4 v6, s[16:19], s41 offen lds
    s_mov_b32 m0, 17408
    s_add_u32 s41, s45, 8192
    buffer_load_dwordx4 v7, s[16:19], s41 offen lds
    s_mov_b32 m0, 18432
    s_add_u32 s41, s45, 16384
    buffer_load_dwordx4 v6, s[16:19], s41 offen lds
    s_mov_b32 m0, 19456
    s_add_u32 s41, s45, 24576
    buffer_load_dwordx4 v7, s[16:19], s41 offen lds
    s_mov_b32 m0, 20480
    s_add_u32 s41, s45, 32768
    buffer_load_dwordx4 v6, s[16:19], s41 offen lds
    s_mov_b32 m0, 21504
    s_add_u32 s41, s45, 40960
    buffer_load_dwordx4 v7, s[16:19], s41 offen lds
    s_mov_b32 m0, 22528
    s_add_u32 s41, s45, 49152
    buffer_load_dwordx4 v6, s[16:19], s41 offen lds
    s_mov_b32 m0, 23552
    s_add_u32 s41, s45, 57344
    buffer_load_dwordx4 v7, s[16:19], s41 offen lds
    s_waitcnt vmcnt(8)
    s_barrier
    s_add_u32 s53, s75, 4
    s_and_b32 s53, s53, 7
    s_mul_i32 s45, s53, 128
    s_add_u32 s45, s45, s46
    s_mov_b32 m0, 40960
    s_add_u32 s41, s45, 0
    buffer_load_dwordx4 v6, s[16:19], s41 offen lds
    s_mov_b32 m0, 41984
    s_add_u32 s41, s45, 8192
    buffer_load_dwordx4 v7, s[16:19], s41 offen lds
    s_mov_b32 m0, 43008
    s_add_u32 s41, s45, 16384
    buffer_load_dwordx4 v6, s[16:19], s41 offen lds
    s_mov_b32 m0, 44032
    s_add_u32 s41, s45, 24576
    buffer_load_dwordx4 v7, s[16:19], s41 offen lds
    s_mov_b32 m0, 45056
    s_add_u32 s41, s45, 32768
    buffer_load_dwordx4 v6, s[16:19], s41 offen lds
    s_mov_b32 m0, 46080
    s_add_u32 s41, s45, 40960
    buffer_load_dwordx4 v7, s[16:19], s41 offen lds
    s_mov_b32 m0, 47104
    s_add_u32 s41, s45, 49152
    buffer_load_dwordx4 v6, s[16:19], s41 offen lds
    s_mov_b32 m0, 48128
    s_add_u32 s41, s45, 57344
    buffer_load_dwordx4 v7, s[16:19], s41 offen lds
    s_waitcnt vmcnt(8)
    s_barrier
    s_add_u32 s53, s75, 5
    s_and_b32 s53, s53, 7
    s_mul_i32 s45, s53, 128
    s_add_u32 s45, s45, s46
    s_mov_b32 m0, 65536
    s_add_u32 s41, s45, 0
    buffer_load_dwordx4 v6, s[16:19], s41 offen lds
    s_mov_b32 m0, 66560
    s_add_u32 s41, s45, 8192
    buffer_load_dwordx4 v7, s[16:19], s41 offen lds
    s_mov_b32 m0, 67584
    s_add_u32 s41, s45, 16384
    buffer_load_dwordx4 v6, s[16:19], s41 offen lds
    s_mov_b32 m0, 68608
    s_add_u32 s41, s45, 24576
    buffer_load_dwordx4 v7, s[16:19], s41 offen lds
    s_mov_b32 m0, 69632
    s_add_u32 s41, s45, 32768
    buffer_load_dwordx4 v6, s[16:19], s41 offen lds
    s_mov_b32 m0, 70656
    s_add_u32 s41, s45, 40960
    buffer_load_dwordx4 v7, s[16:19], s41 offen lds
    s_mov_b32 m0, 71680
    s_add_u32 s41, s45, 49152
    buffer_load_dwordx4 v6, s[16:19], s41 offen lds
    s_mov_b32 m0, 72704
    s_add_u32 s41, s45, 57344
    buffer_load_dwordx4 v7, s[16:19], s41 offen lds
    s_waitcnt vmcnt(8)
    s_barrier
    s_add_u32 s53, s75, 6
    s_and_b32 s53, s53, 7
    s_mul_i32 s45, s53, 128
    s_add_u32 s45, s45, s46
    s_mov_b32 m0, 16384
    s_add_u32 s41, s45, 0
    buffer_load_dwordx4 v6, s[16:19], s41 offen lds
    s_mov_b32 m0, 17408
    s_add_u32 s41, s45, 8192
    buffer_load_dwordx4 v7, s[16:19], s41 offen lds
    s_mov_b32 m0, 18432
    s_add_u32 s41, s45, 16384
    buffer_load_dwordx4 v6, s[16:19], s41 offen lds
    s_mov_b32 m0, 19456
    s_add_u32 s41, s45, 24576
    buffer_load_dwordx4 v7, s[16:19], s41 offen lds
    s_mov_b32 m0, 20480
    s_add_u32 s41, s45, 32768
    buffer_load_dwordx4 v6, s[16:19], s41 offen lds
    s_mov_b32 m0, 21504
    s_add_u32 s41, s45, 40960
    buffer_load_dwordx4 v7, s[16:19], s41 offen lds
    s_mov_b32 m0, 22528
    s_add_u32 s41, s45, 49152
    buffer_load_dwordx4 v6, s[16:19], s41 offen lds
    s_mov_b32 m0, 23552
    s_add_u32 s41, s45, 57344
    buffer_load_dwordx4 v7, s[16:19], s41 offen lds
    s_waitcnt vmcnt(8)
    s_barrier
    s_add_u32 s53, s75, 7
    s_and_b32 s53, s53, 7
    s_mul_i32 s45, s53, 128
    s_add_u32 s45, s45, s46
    s_mov_b32 m0, 40960
    s_add_u32 s41, s45, 0
    buffer_load_dwordx4 v6, s[16:19], s41 offen lds
    s_mov_b32 m0, 41984
    s_add_u32 s41, s45, 8192
    buffer_load_dwordx4 v7, s[16:19], s41 offen lds
    s_mov_b32 m0, 43008
    s_add_u32 s41, s45, 16384
    buffer_load_dwordx4 v6, s[16:19], s41 offen lds
    s_mov_b32 m0, 44032
    s_add_u32 s41, s45, 24576
    buffer_load_dwordx4 v7, s[16:19], s41 offen lds
    s_mov_b32 m0, 45056
    s_add_u32 s41, s45, 32768
    buffer_load_dwordx4 v6, s[16:19], s41 offen lds
    s_mov_b32 m0, 46080
    s_add_u32 s41, s45, 40960
    buffer_load_dwordx4 v7, s[16:19], s41 offen lds
    s_mov_b32 m0, 47104
    s_add_u32 s41, s45, 49152
    buffer_load_dwordx4 v6, s[16:19], s41 offen lds
    s_mov_b32 m0, 48128
    s_add_u32 s41, s45, 57344
    buffer_load_dwordx4 v7, s[16:19], s41 offen lds
    s_waitcnt vmcnt(8)
    s_barrier
    s_setprio 0
    s_add_u32 s53, s74, 0
    s_and_b32 s53, s53, 7
    s_mul_i32 s45, s53, 128
    s_add_u32 s45, s45, s47
    s_mov_b32 m0, 65536
    s_add_u32 s41, s45, 0
    buffer_load_dwordx4 v6, s[16:19], s41 offen lds
    s_mov_b32 m0, 66560
    s_add_u32 s41, s45, 8192
    buffer_load_dwordx4 v7, s[16:19], s41 offen lds
    s_mov_b32 m0, 67584
    s_add_u32 s41, s45, 16384
    buffer_load_dwordx4 v6, s[16:19], s41 offen lds
    s_mov_b32 m0, 68608
    s_add_u32 s41, s45, 24576
    buffer_load_dwordx4 v7, s[16:19], s41 offen lds
    s_mov_b32 m0, 69632
    s_add_u32 s41, s45, 32768
    buffer_load_dwordx4 v6, s[16:19], s41 offen lds
    s_mov_b32 m0, 70656
    s_add_u32 s41, s45, 40960
    buffer_load_dwordx4 v7, s[16:19], s41 offen lds
    s_mov_b32 m0, 71680
    s_add_u32 s41, s45, 49152
    buffer_load_dwordx4 v6, s[16:19], s41 offen lds
    s_mov_b32 m0, 72704
    s_add_u32 s41, s45, 57344
    buffer_load_dwordx4 v7, s[16:19], s41 offen lds
    s_waitcnt vmcnt(8)
    s_barrier
    s_add_u32 s53, s74, 1
    s_and_b32 s53, s53, 7
    s_mul_i32 s45, s53, 128
    s_add_u32 s45, s45, s47
    s_mov_b32 m0, 16384
    s_add_u32 s41, s45, 0
    buffer_load_dwordx4 v6, s[16:19], s41 offen lds
    s_mov_b32 m0, 17408
    s_add_u32 s41, s45, 8192
    buffer_load_dwordx4 v7, s[16:19], s41 offen lds
    s_mov_b32 m0, 18432
    s_add_u32 s41, s45, 16384
    buffer_load_dwordx4 v6, s[16:19], s41 offen lds
    s_mov_b32 m0, 19456
    s_add_u32 s41, s45, 24576
    buffer_load_dwordx4 v7, s[16:19], s41 offen lds
    s_mov_b32 m0, 20480
    s_add_u32 s41, s45, 32768
    buffer_load_dwordx4 v6, s[16:19], s41 offen lds
    s_mov_b32 m0, 21504
    s_add_u32 s41, s45, 40960
    buffer_load_dwordx4 v7, s[16:19], s41 offen lds
    s_mov_b32 m0, 22528
    s_add_u32 s41, s45, 49152
    buffer_load_dwordx4 v6, s[16:19], s41 offen lds
    s_mov_b32 m0, 23552
    s_add_u32 s41, s45, 57344
    buffer_load_dwordx4 v7, s[16:19], s41 offen lds
    s_waitcnt vmcnt(8)
    s_barrier
    s_add_u32 s53, s74, 2
    s_and_b32 s53, s53, 7
    s_mul_i32 s45, s53, 128
    s_add_u32 s45, s45, s47
    s_mov_b32 m0, 40960
    s_add_u32 s41, s45, 0
    buffer_load_dwordx4 v6, s[16:19], s41 offen lds
    s_mov_b32 m0, 41984
    s_add_u32 s41, s45, 8192
    buffer_load_dwordx4 v7, s[16:19], s41 offen lds
    s_mov_b32 m0, 43008
    s_add_u32 s41, s45, 16384
    buffer_load_dwordx4 v6, s[16:19], s41 offen lds
    s_mov_b32 m0, 44032
    s_add_u32 s41, s45, 24576
    buffer_load_dwordx4 v7, s[16:19], s41 offen lds
    s_mov_b32 m0, 45056
    s_add_u32 s41, s45, 32768
    buffer_load_dwordx4 v6, s[16:19], s41 offen lds
    s_mov_b32 m0, 46080
    s_add_u32 s41, s45, 40960
    buffer_load_dwordx4 v7, s[16:19], s41 offen lds
    s_mov_b32 m0, 47104
    s_add_u32 s41, s45, 49152
    buffer_load_dwordx4 v6, s[16:19], s41 offen lds
    s_mov_b32 m0, 48128
    s_add_u32 s41, s45, 57344
    buffer_load_dwordx4 v7, s[16:19], s41 offen lds
    s_waitcnt vmcnt(8)
    s_barrier
    s_add_u32 s53, s74, 3
    s_and_b32 s53, s53, 7
    s_mul_i32 s45, s53, 128
    s_add_u32 s45, s45, s47
    s_mov_b32 m0, 65536
    s_add_u32 s41, s45, 0
    buffer_load_dwordx4 v6, s[16:19], s41 offen lds
    s_mov_b32 m0, 66560
    s_add_u32 s41, s45, 8192
    buffer_load_dwordx4 v7, s[16:19], s41 offen lds
    s_mov_b32 m0, 67584
    s_add_u32 s41, s45, 16384
    buffer_load_dwordx4 v6, s[16:19], s41 offen lds
    s_mov_b32 m0, 68608
    s_add_u32 s41, s45, 24576
    buffer_load_dwordx4 v7, s[16:19], s41 offen lds
    s_mov_b32 m0, 69632
    s_add_u32 s41, s45, 32768
    buffer_load_dwordx4 v6, s[16:19], s41 offen lds
    s_mov_b32 m0, 70656
    s_add_u32 s41, s45, 40960
    buffer_load_dwordx4 v7, s[16:19], s41 offen lds
    s_mov_b32 m0, 71680
    s_add_u32 s41, s45, 49152
    buffer_load_dwordx4 v6, s[16:19], s41 offen lds
    s_mov_b32 m0, 72704
    s_add_u32 s41, s45, 57344
    buffer_load_dwordx4 v7, s[16:19], s41 offen lds
    s_waitcnt vmcnt(8)
    s_barrier
    s_add_u32 s53, s74, 4
    s_and_b32 s53, s53, 7
    s_mul_i32 s45, s53, 128
    s_add_u32 s45, s45, s47
    s_mov_b32 m0, 16384
    s_add_u32 s41, s45, 0
    buffer_load_dwordx4 v6, s[16:19], s41 offen lds
    s_mov_b32 m0, 17408
    s_add_u32 s41, s45, 8192
    buffer_load_dwordx4 v7, s[16:19], s41 offen lds
    s_mov_b32 m0, 18432
    s_add_u32 s41, s45, 16384
    buffer_load_dwordx4 v6, s[16:19], s41 offen lds
    s_mov_b32 m0, 19456
    s_add_u32 s41, s45, 24576
    buffer_load_dwordx4 v7, s[16:19], s41 offen lds
    s_mov_b32 m0, 20480
    s_add_u32 s41, s45, 32768
    buffer_load_dwordx4 v6, s[16:19], s41 offen lds
    s_mov_b32 m0, 21504
    s_add_u32 s41, s45, 40960
    buffer_load_dwordx4 v7, s[16:19], s41 offen lds
    s_mov_b32 m0, 22528
    s_add_u32 s41, s45, 49152
    buffer_load_dwordx4 v6, s[16:19], s41 offen lds
    s_mov_b32 m0, 23552
    s_add_u32 s41, s45, 57344
    buffer_load_dwordx4 v7, s[16:19], s41 offen lds
    s_waitcnt vmcnt(8)
    s_barrier
    s_add_u32 s53, s74, 5
    s_and_b32 s53, s53, 7
    s_mul_i32 s45, s53, 128
    s_add_u32 s45, s45, s47
    s_mov_b32 m0, 40960
    s_add_u32 s41, s45, 0
    buffer_load_dwordx4 v6, s[16:19], s41 offen lds
    s_mov_b32 m0, 41984
    s_add_u32 s41, s45, 8192
    buffer_load_dwordx4 v7, s[16:19], s41 offen lds
    s_mov_b32 m0, 43008
    s_add_u32 s41, s45, 16384
    buffer_load_dwordx4 v6, s[16:19], s41 offen lds
    s_mov_b32 m0, 44032
    s_add_u32 s41, s45, 24576
    buffer_load_dwordx4 v7, s[16:19], s41 offen lds
    s_mov_b32 m0, 45056
    s_add_u32 s41, s45, 32768
    buffer_load_dwordx4 v6, s[16:19], s41 offen lds
    s_mov_b32 m0, 46080
    s_add_u32 s41, s45, 40960
    buffer_load_dwordx4 v7, s[16:19], s41 offen lds
    s_mov_b32 m0, 47104
    s_add_u32 s41, s45, 49152
    buffer_load_dwordx4 v6, s[16:19], s41 offen lds
    s_mov_b32 m0, 48128
    s_add_u32 s41, s45, 57344
    buffer_load_dwordx4 v7, s[16:19], s41 offen lds
    s_waitcnt vmcnt(8)
    s_barrier
    s_add_u32 s53, s74, 6
    s_and_b32 s53, s53, 7
    s_mul_i32 s45, s53, 128
    s_add_u32 s45, s45, s47
    s_mov_b32 m0, 65536
    s_add_u32 s41, s45, 0
    buffer_load_dwordx4 v6, s[16:19], s41 offen lds
    s_mov_b32 m0, 66560
    s_add_u32 s41, s45, 8192
    buffer_load_dwordx4 v7, s[16:19], s41 offen lds
    s_mov_b32 m0, 67584
    s_add_u32 s41, s45, 16384
    buffer_load_dwordx4 v6, s[16:19], s41 offen lds
    s_mov_b32 m0, 68608
    s_add_u32 s41, s45, 24576
    buffer_load_dwordx4 v7, s[16:19], s41 offen lds
    s_mov_b32 m0, 69632
    s_add_u32 s41, s45, 32768
    buffer_load_dwordx4 v6, s[16:19], s41 offen lds
    s_mov_b32 m0, 70656
    s_add_u32 s41, s45, 40960
    buffer_load_dwordx4 v7, s[16:19], s41 offen lds
    s_mov_b32 m0, 71680
    s_add_u32 s41, s45, 49152
    buffer_load_dwordx4 v6, s[16:19], s41 offen lds
    s_mov_b32 m0, 72704
    s_add_u32 s41, s45, 57344
    buffer_load_dwordx4 v7, s[16:19], s41 offen lds
    s_waitcnt vmcnt(8)
    s_barrier
    s_add_u32 s53, s74, 7
    s_and_b32 s53, s53, 7
    s_mul_i32 s45, s53, 128
    s_add_u32 s45, s45, s47
    s_mov_b32 m0, 16384
    s_add_u32 s41, s45, 0
    buffer_load_dwordx4 v6, s[16:19], s41 offen lds
    s_mov_b32 m0, 17408
    s_add_u32 s41, s45, 8192
    buffer_load_dwordx4 v7, s[16:19], s41 offen lds
    s_mov_b32 m0, 18432
    s_add_u32 s41, s45, 16384
    buffer_load_dwordx4 v6, s[16:19], s41 offen lds
    s_mov_b32 m0, 19456
    s_add_u32 s41, s45, 24576
    buffer_load_dwordx4 v7, s[16:19], s41 offen lds
    s_mov_b32 m0, 20480
    s_add_u32 s41, s45, 32768
    buffer_load_dwordx4 v6, s[16:19], s41 offen lds
    s_mov_b32 m0, 21504
    s_add_u32 s41, s45, 40960
    buffer_load_dwordx4 v7, s[16:19], s41 offen lds
    s_mov_b32 m0, 22528
    s_add_u32 s41, s45, 49152
    buffer_load_dwordx4 v6, s[16:19], s41 offen lds
    s_mov_b32 m0, 23552
    s_add_u32 s41, s45, 57344
    buffer_load_dwordx4 v7, s[16:19], s41 offen lds
    s_waitcnt vmcnt(8)
    s_barrier
    s_mov_b32 m0, 40960
    s_add_u32 s41, s40, 0
    buffer_load_dwordx4 v4, s[8:11], s41 offen offset:0 lds
    buffer_load_dwordx4 v5, s[8:11], s41 offen offset:1024 lds
    s_add_u32 s41, s40, 63488
    buffer_load_dwordx4 v4, s[8:11], s41 offen offset:2048 lds
    buffer_load_dwordx4 v5, s[8:11], s41 offen offset:3072 lds
    s_mov_b32 m0, 45056
    s_add_u32 s41, s40, 131072
    buffer_load_dwordx4 v4, s[8:11], s41 offen offset:0 lds
    buffer_load_dwordx4 v5, s[8:11], s41 offen offset:1024 lds
    s_add_u32 s41, s40, 194560
    buffer_load_dwordx4 v4, s[8:11], s41 offen offset:2048 lds
    buffer_load_dwordx4 v5, s[8:11], s41 offen offset:3072 lds
    s_add_u32 s43, s43, 128
    s_and_b32 s43, s43, 0xfff
    s_add_u32 s40, s42, s43
    s_waitcnt vmcnt(8)
    s_barrier
    s_mov_b32 m0, 65536
    s_add_u32 s41, s40, 0
    buffer_load_dwordx4 v4, s[8:11], s41 offen offset:0 lds
    buffer_load_dwordx4 v5, s[8:11], s41 offen offset:1024 lds
    s_add_u32 s41, s40, 63488
    buffer_load_dwordx4 v4, s[8:11], s41 offen offset:2048 lds
    buffer_load_dwordx4 v5, s[8:11], s41 offen offset:3072 lds
    s_mov_b32 m0, 69632
    s_add_u32 s41, s40, 131072
    buffer_load_dwordx4 v4, s[8:11], s41 offen offset:0 lds
    buffer_load_dwordx4 v5, s[8:11], s41 offen offset:1024 lds
    s_add_u32 s41, s40, 194560
    buffer_load_dwordx4 v4, s[8:11], s41 offen offset:2048 lds
    buffer_load_dwordx4 v5, s[8:11], s41 offen offset:3072 lds
    s_add_u32 s43, s43, 128
    s_and_b32 s43, s43, 0xfff
    s_add_u32 s40, s42, s43
    s_setprio 2
    s_mov_b32 s54, 0
kf_lw:
    s_waitcnt vmcnt(8)
    s_barrier
    s_mov_b32 m0, 16384
    s_add_u32 s41, s40, 0
    buffer_load_dwordx4 v4, s[8:11], s41 offen offset:0 lds
    buffer_load_dwordx4 v5, s[8:11], s41 offen offset:1024 lds
    s_add_u32 s41, s40, 63488
    buffer_load_dwordx4 v4, s[8:11], s41 offen offset:2048 lds
    buffer_load_dwordx4 v5, s[8:11], s41 offen offset:3072 lds
    s_mov_b32 m0, 20480
    s_add_u32 s41, s40, 131072
    buffer_load_dwordx4 v4, s[8:11], s41 offen offset:0 lds
    buffer_load_dwordx4 v5, s[8:11], s41 offen offset:1024 lds
    s_add_u32 s41, s40, 194560
    buffer_load_dwordx4 v4, s[8:11], s41 offen offset:2048 lds
    buffer_load_dwordx4 v5, s[8:11], s41 offen offset:3072 lds
    s_add_u32 s43, s43, 128
    s_and_b32 s43, s43, 0xfff
    s_add_u32 s40, s42, s43
    s_waitcnt vmcnt(8)
    s_barrier
    s_mov_b32 m0, 40960
    s_add_u32 s41, s40, 0
    buffer_load_dwordx4 v4, s[8:11], s41 offen offset:0 lds
    buffer_load_dwordx4 v5, s[8:11], s41 offen offset:1024 lds
    s_add_u32 s41, s40, 63488
    buffer_load_dwordx4 v4, s[8:11], s41 offen offset:2048 lds
    buffer_load_dwordx4 v5, s[8:11], s41 offen offset:3072 lds
    s_mov_b32 m0, 45056
    s_add_u32 s41, s40, 131072
    buffer_load_dwordx4 v4, s[8:11], s41 offen offset:0 lds
    buffer_load_dwordx4 v5, s[8:11], s41 offen offset:1024 lds
    s_add_u32 s41, s40, 194560
    buffer_load_dwordx4 v4, s[8:11], s41 offen offset:2048 lds
    buffer_load_dwordx4 v5, s[8:11], s41 offen offset:3072 lds
    s_add_u32 s43, s43, 128
    s_and_b32 s43, s43, 0xfff
    s_add_u32 s40, s42, s43
    s_waitcnt vmcnt(8)
    s_barrier
    s_mov_b32 m0, 65536
    s_add_u32 s41, s40, 0
    buffer_load_dwordx4 v4, s[8:11], s41 offen offset:0 lds
    buffer_load_dwordx4 v5, s[8:11], s41 offen offset:1024 lds
    s_add_u32 s41, s40, 63488
    buffer_load_dwordx4 v4, s[8:11], s41 offen offset:2048 lds
    buffer_load_dwordx4 v5, s[8:11], s41 offen offset:3072 lds
    s_mov_b32 m0, 69632
    s_add_u32 s41, s40, 131072
    buffer_load_dwordx4 v4, s[8:11], s41 offen offset:0 lds
    buffer_load_dwordx4 v5, s[8:11], s41 offen offset:1024 lds
    s_add_u32 s41, s40, 194560
    buffer_load_dwordx4 v4, s[8:11], s41 offen offset:2048 lds
    buffer_load_dwordx4 v5, s[8:11], s41 offen offset:3072 lds
    s_add_u32 s43, s43, 128
    s_and_b32 s43, s43, 0xfff
    s_add_u32 s40, s42, s43
    s_add_u32 s54, s54, 1
    s_cmp_lt_u32 s54, 10
    s_cbranch_scc1 kf_lw
    s_branch k2_pre
kf_alw:
    s_sub_u32 s44, s32, 4
    s_lshl_b32 s42, s44, 12
    s_lshl_b32 s40, s44, 10
    s_lshl_b32 s44, s57, 7
    s_add_u32 s40, s40, s44
    v_lshrrev_b32 v5, 3, v1
    v_mul_u32_u24 v5, 3072, v5
    v_and_b32 v4, 7, v1
    v_bfe_u32 v6, v1, 4, 1
    v_lshlrev_b32 v6, 2, v6
    v_xor_b32 v4, v4, v6
    v_lshl_add_u32 v4, v4, 4, v5
    s_waitcnt lgkmcnt(0)
    s_add_u32 s53, s75, 1
    s_and_b32 s53, s53, 7
    s_mul_i32 s45, s53, 196608
    s_add_u32 s45, s45, s40
    s_add_u32 m0, s42, 24576
    s_add_u32 s41, s45, 0
    buffer_load_dwordx4 v4, s[20:23], s41 offen lds
    s_add_u32 m0, s42, 25600
    s_add_u32 s41, s45, 24576
    buffer_load_dwordx4 v4, s[20:23], s41 offen lds
    s_add_u32 m0, s42, 26624
    s_add_u32 s41, s45, 49152
    buffer_load_dwordx4 v4, s[20:23], s41 offen lds
    s_add_u32 m0, s42, 27648
    s_add_u32 s41, s45, 73728
    buffer_load_dwordx4 v4, s[20:23], s41 offen lds
    s_waitcnt vmcnt(4)
    s_barrier
    s_add_u32 m0, s42, 36864
    s_add_u32 s41, s45, 98304
    buffer_load_dwordx4 v4, s[20:23], s41 offen lds
    s_add_u32 m0, s42, 37888
    s_add_u32 s41, s45, 122880
    buffer_load_dwordx4 v4, s[20:23], s41 offen lds
    s_add_u32 m0, s42, 38912
    s_add_u32 s41, s45, 147456
    buffer_load_dwordx4 v4, s[20:23], s41 offen lds
    s_add_u32 m0, s42, 39936
    s_add_u32 s41, s45, 172032
    buffer_load_dwordx4 v4, s[20:23], s41 offen lds
    s_barrier
    s_add_u32 s53, s75, 2
    s_and_b32 s53, s53, 7
    s_mul_i32 s45, s53, 196608
    s_add_u32 s45, s45, s40
    s_add_u32 m0, s42, 0
    s_add_u32 s41, s45, 0
    buffer_load_dwordx4 v4, s[20:23], s41 offen lds
    s_add_u32 m0, s42, 1024
    s_add_u32 s41, s45, 24576
    buffer_load_dwordx4 v4, s[20:23], s41 offen lds
    s_add_u32 m0, s42, 2048
    s_add_u32 s41, s45, 49152
    buffer_load_dwordx4 v4, s[20:23], s41 offen lds
    s_add_u32 m0, s42, 3072
    s_add_u32 s41, s45, 73728
    buffer_load_dwordx4 v4, s[20:23], s41 offen lds
    s_waitcnt vmcnt(8)
    s_barrier
    s_add_u32 m0, s42, 12288
    s_add_u32 s41, s45, 98304
    buffer_load_dwordx4 v4, s[20:23], s41 offen lds
    s_add_u32 m0, s42, 13312
    s_add_u32 s41, s45, 122880
    buffer_load_dwordx4 v4, s[20:23], s41 offen lds
    s_add_u32 m0, s42, 14336
    s_add_u32 s41, s45, 147456
    buffer_load_dwordx4 v4, s[20:23], s41 offen lds
    s_add_u32 m0, s42, 15360
    s_add_u32 s41, s45, 172032
    buffer_load_dwordx4 v4, s[20:23], s41 offen lds
    s_waitcnt vmcnt(8)
    s_barrier
    s_add_u32 s53, s75, 3
    s_and_b32 s53, s53, 7
    s_mul_i32 s45, s53, 196608
    s_add_u32 s45, s45, s40
    s_add_u32 m0, s42, 24576
    s_add_u32 s41, s45, 0
    buffer_load_dwordx4 v4, s[20:23], s41 offen lds
    s_add_u32 m0, s42, 25600
    s_add_u32 s41, s45, 24576
    buffer_load_dwordx4 v4, s[20:23], s41 offen lds
    s_add_u32 m0, s42, 26624
    s_add_u32 s41, s45, 49152
    buffer_load_dwordx4 v4, s[20:23], s41 offen lds
    s_add_u32 m0, s42, 27648
    s_add_u32 s41, s45, 73728
    buffer_load_dwordx4 v4, s[20:23], s41 offen lds
    s_waitcnt vmcnt(8)
    s_barrier
    s_add_u32 m0, s42, 36864
    s_add_u32 s41, s45, 98304
    buffer_load_dwordx4 v4, s[20:23], s41 offen lds
    s_add_u32 m0, s42, 37888
    s_add_u32 s41, s45, 122880
    buffer_load_dwordx4 v4, s[20:23], s41 offen lds
    s_add_u32 m0, s42, 38912
    s_add_u32 s41, s45, 147456
    buffer_load_dwordx4 v4, s[20:23], s41 offen lds
    s_add_u32 m0, s42, 39936
    s_add_u32 s41, s45, 172032
    buffer_load_dwordx4 v4, s[20:23], s41 offen lds
    s_waitcnt vmcnt(8)
    s_barrier
    s_add_u32 s53, s75, 4
    s_and_b32 s53, s53, 7
    s_mul_i32 s45, s53, 196608
    s_add_u32 s45, s45, s40
    s_add_u32 m0, s42, 0
    s_add_u32 s41, s45, 0
    buffer_load_dwordx4 v4, s[20:23], s41 offen lds
    s_add_u32 m0, s42, 1024
    s_add_u32 s41, s45, 24576
    buffer_load_dwordx4 v4, s[20:23], s41 offen lds
    s_add_u32 m0, s42, 2048
    s_add_u32 s41, s45, 49152
    buffer_load_dwordx4 v4, s[20:23], s41 offen lds
    s_add_u32 m0, s42, 3072
    s_add_u32 s41, s45, 73728
    buffer_load_dwordx4 v4, s[20:23], s41 offen lds
    s_waitcnt vmcnt(8)
    s_barrier
    s_add_u32 m0, s42, 12288
    s_add_u32 s41, s45, 98304
    buffer_load_dwordx4 v4, s[20:23], s41 offen lds
    s_add_u32 m0, s42, 13312
    s_add_u32 s41, s45, 122880
    buffer_load_dwordx4 v4, s[20:23], s41 offen lds
    s_add_u32 m0, s42, 14336
    s_add_u32 s41, s45, 147456
    buffer_load_dwordx4 v4, s[20:23], s41 offen lds
    s_add_u32 m0, s42, 15360
    s_add_u32 s41, s45, 172032
    buffer_load_dwordx4 v4, s[20:23], s41 offen lds
    s_waitcnt vmcnt(8)
    s_barrier
    s_add_u32 s53, s75, 5
    s_and_b32 s53, s53, 7
    s_mul_i32 s45, s53, 196608
    s_add_u32 s45, s45, s40
    s_add_u32 m0, s42, 24576
    s_add_u32 s41, s45, 0
    buffer_load_dwordx4 v4, s[20:23], s41 offen lds
    s_add_u32 m0, s42, 25600
    s_add_u32 s41, s45, 24576
    buffer_load_dwordx4 v4, s[20:23], s41 offen lds
    s_add_u32 m0, s42, 26624
    s_add_u32 s41, s45, 49152
    buffer_load_dwordx4 v4, s[20:23], s41 offen lds
    s_add_u32 m0, s42, 27648
    s_add_u32 s41, s45, 73728
    buffer_load_dwordx4 v4, s[20:23], s41 offen lds
    s_waitcnt vmcnt(8)
    s_barrier
    s_add_u32 m0, s42, 36864
    s_add_u32 s41, s45, 98304
    buffer_load_dwordx4 v4, s[20:23], s41 offen lds
    s_add_u32 m0, s42, 37888
    s_add_u32 s41, s45, 122880
    buffer_load_dwordx4 v4, s[20:23], s41 offen lds
    s_add_u32 m0, s42, 38912
    s_add_u32 s41, s45, 147456
    buffer_load_dwordx4 v4, s[20:23], s41 offen lds
    s_add_u32 m0, s42, 39936
    s_add_u32 s41, s45, 172032
    buffer_load_dwordx4 v4, s[20:23], s41 offen lds
    s_waitcnt vmcnt(8)
    s_barrier
    s_add_u32 s53, s75, 6
    s_and_b32 s53, s53, 7
    s_mul_i32 s45, s53, 196608
    s_add_u32 s45, s45, s40
    s_add_u32 m0, s42, 0
    s_add_u32 s41, s45, 0
    buffer_load_dwordx4 v4, s[20:23], s41 offen lds
    s_add_u32 m0, s42, 1024
    s_add_u32 s41, s45, 24576
    buffer_load_dwordx4 v4, s[20:23], s41 offen lds
    s_add_u32 m0, s42, 2048
    s_add_u32 s41, s45, 49152
    buffer_load_dwordx4 v4, s[20:23], s41 offen lds
    s_add_u32 m0, s42, 3072
    s_add_u32 s41, s45, 73728
    buffer_load_dwordx4 v4, s[20:23], s41 offen lds
    s_waitcnt vmcnt(8)
    s_barrier
    s_add_u32 m0, s42, 12288
    s_add_u32 s41, s45, 98304
    buffer_load_dwordx4 v4, s[20:23], s41 offen lds
    s_add_u32 m0, s42, 13312
    s_add_u32 s41, s45, 122880
    buffer_load_dwordx4 v4, s[20:23], s41 offen lds
    s_add_u32 m0, s42, 14336
    s_add_u32 s41, s45, 147456
    buffer_load_dwordx4 v4, s[20:23], s41 offen lds
    s_add_u32 m0, s42, 15360
    s_add_u32 s41, s45, 172032
    buffer_load_dwordx4 v4, s[20:23], s41 offen lds
    s_waitcnt vmcnt(8)
    s_barrier
    s_add_u32 s53, s75, 7
    s_and_b32 s53, s53, 7
    s_mul_i32 s45, s53, 196608
    s_add_u32 s45, s45, s40
    s_add_u32 m0, s42, 24576
    s_add_u32 s41, s45, 0
    buffer_load_dwordx4 v4, s[20:23], s41 offen lds
    s_add_u32 m0, s42, 25600
    s_add_u32 s41, s45, 24576
    buffer_load_dwordx4 v4, s[20:23], s41 offen lds
    s_add_u32 m0, s42, 26624
    s_add_u32 s41, s45, 49152
    buffer_load_dwordx4 v4, s[20:23], s41 offen lds
    s_add_u32 m0, s42, 27648
    s_add_u32 s41, s45, 73728
    buffer_load_dwordx4 v4, s[20:23], s41 offen lds
    s_waitcnt vmcnt(8)
    s_barrier
    s_add_u32 m0, s42, 36864
    s_add_u32 s41, s45, 98304
    buffer_load_dwordx4 v4, s[20:23], s41 offen lds
    s_add_u32 m0, s42, 37888
    s_add_u32 s41, s45, 122880
    buffer_load_dwordx4 v4, s[20:23], s41 offen lds
    s_add_u32 m0, s42, 38912
    s_add_u32 s41, s45, 147456
    buffer_load_dwordx4 v4, s[20:23], s41 offen lds
    s_add_u32 m0, s42, 39936
    s_add_u32 s41, s45, 172032
    buffer_load_dwordx4 v4, s[20:23], s41 offen lds
    s_waitcnt vmcnt(8)
    s_barrier
    s_waitcnt vmcnt(4)
    s_barrier
    s_waitcnt vmcnt(0)
    s_barrier
    s_setprio 0
    s_branch kf_ax
kf_ac:
    s_and_b32 s44, s32, 1
    s_lshr_b32 s46, s32, 1
    s_lshl_b32 s45, s44, 12
    s_add_u32 s45, s45, 49152
    s_lshl_b32 s47, s46, 6
    v_bfe_u32 v9, v1, 1, 3
    v_xor_b32 v9, v9, v3
    v_lshlrev_b32 v9, 4, v9
    v_lshl_add_u32 v4, v2, 7, v9
    v_add_u32 v4, s45, v4
    v_xor_b32 v5, 32, v4
    v_xor_b32 v6, 64, v4
    v_xor_b32 v7, 96, v4
    v_bfe_u32 v9, v1, 2, 2
    v_lshl_add_u32 v9, v3, 3, v9
    v_and_b32 v10, 1, v1
    v_bfe_u32 v11, v1, 1, 1
    v_lshl_add_u32 v10, v10, 1, v11
    v_lshlrev_b32 v10, 3, v10
    v_bfe_u32 v11, v1, 4, 1
    v_lshl_add_u32 v10, v11, 5, v10
    v_add_u32 v10, s47, v10
    v_bfe_u32 v11, v1, 3, 1
    v_lshlrev_b32 v11, 6, v11
    v_xor_b32 v10, v10, v11
    v_lshl_add_u32 v8, v9, 7, v10
    s_lshl_b32 s60, s57, 2
    s_lshl_b32 s47, s46, 1
    s_add_u32 s60, s60, s47
    s_lshl_b32 s60, s60, 16
    s_lshl_b32 s47, s56, 1
    s_add_u32 s47, s47, s44
    s_lshl_b32 s47, s47, 10
    s_add_u32 s60, s60, s47
    v_lshlrev_b32 v12, 4, v1
    v_bfe_u32 v13, v1, 4, 1
    v_lshlrev_b32 v13, 16, v13
    v_lshl_add_u32 v13, v3, 8, v13
    v_and_b32 v9, 15, v1
    v_lshl_add_u32 v13, v9, 4, v13
    s_mov_b32 s52, 0x3eb8aa3b
    s_waitcnt vmcnt(0) lgkmcnt(0)
    s_barrier
    ds_read_b128 v[16:19], v4 offset:0
    ds_read_b64_tr_b16 v[20:21], v8 offset:0
    ds_read_b64_tr_b16 v[22:23], v8 offset:512
    ds_read_b64_tr_b16 v[24:25], v8 offset:4096
    ds_read_b64_tr_b16 v[26:27], v8 offset:4608
    ds_read_b64_tr_b16 v[28:29], v8 offset:8192
    ds_read_b64_tr_b16 v[30:31], v8 offset:8704
    ds_read_b128 v[32:35], v5 offset:0
    ds_read_b64_tr_b16 v[36:37], v8 offset:2048
    ds_read_b64_tr_b16 v[38:39], v8 offset:2560
    ds_read_b64_tr_b16 v[40:41], v8 offset:6144
    ds_read_b64_tr_b16 v[42:43], v8 offset:6656
    ds_read_b64_tr_b16 v[44:45], v8 offset:10240
    ds_read_b64_tr_b16 v[46:47], v8 offset:10752
    s_waitcnt lgkmcnt(7)
    v_mfma_f32_32x32x16_bf16 v[80:95], v[24:27], v[16:19], 0
    v_mfma_f32_32x32x16_bf16 v[96:111], v[16:19], v[28:31], 0
    v_mfma_f32_32x32x16_bf16 v[64:79], v[20:23], v[16:19], 0
    s_waitcnt lgkmcnt(0)
    s_barrier
    ds_read_b128 v[16:19], v6 offset:0
    ds_read_b64_tr_b16 v[20:21], v8 offset:12288
    ds_read_b64_tr_b16 v[22:23], v8 offset:12800
    ds_read_b64_tr_b16 v[24:25], v8 offset:16384
    ds_read_b64_tr_b16 v[26:27], v8 offset:16896
    ds_read_b64_tr_b16 v[28:29], v8 offset:20480
    ds_read_b64_tr_b16 v[30:31], v8 offset:20992
    v_mfma_f32_32x32x16_bf16 v[80:95], v[40:43], v[32:35], v[80:95]
    v_mfma_f32_32x32x16_bf16 v[96:111], v[32:35], v[44:47], v[96:111]
    v_mfma_f32_32x32x16_bf16 v[64:79], v[36:39], v[32:35], v[64:79]
    ds_read_b128 v[32:35], v7 offset:0
    ds_read_b64_tr_b16 v[36:37], v8 offset:14336
    ds_read_b64_tr_b16 v[38:39], v8 offset:14848
    ds_read_b64_tr_b16 v[40:41], v8 offset:18432
    ds_read_b64_tr_b16 v[42:43], v8 offset:18944
    ds_read_b64_tr_b16 v[44:45], v8 offset:22528
    ds_read_b64_tr_b16 v[46:47], v8 offset:23040
    s_waitcnt lgkmcnt(7)
    v_mfma_f32_32x32x16_bf16 v[80:95], v[24:27], v[16:19], v[80:95]
    v_mfma_f32_32x32x16_bf16 v[96:111], v[16:19], v[28:31], v[96:111]
    v_mfma_f32_32x32x16_bf16 v[64:79], v[20:23], v[16:19], v[64:79]
    s_waitcnt lgkmcnt(0)
    s_barrier
    ds_read_b128 v[16:19], v4 offset:8192
    ds_read_b64_tr_b16 v[20:21], v8 offset:24576
    ds_read_b64_tr_b16 v[22:23], v8 offset:25088
    ds_read_b64_tr_b16 v[24:25], v8 offset:28672
    ds_read_b64_tr_b16 v[26:27], v8 offset:29184
    ds_read_b64_tr_b16 v[28:29], v8 offset:32768
    ds_read_b64_tr_b16 v[30:31], v8 offset:33280
    v_mfma_f32_32x32x16_bf16 v[80:95], v[40:43], v[32:35], v[80:95]
    v_mfma_f32_32x32x16_bf16 v[96:111], v[32:35], v[44:47], v[96:111]
    v_mfma_f32_32x32x16_bf16 v[64:79], v[36:39], v[32:35], v[64:79]
    ds_read_b128 v[32:35], v5 offset:8192
    ds_read_b64_tr_b16 v[36:37], v8 offset:26624
    ds_read_b64_tr_b16 v[38:39], v8 offset:27136
    ds_read_b64_tr_b16 v[40:41], v8 offset:30720
    ds_read_b64_tr_b16 v[42:43], v8 offset:31232
    ds_read_b64_tr_b16 v[44:45], v8 offset:34816
    ds_read_b64_tr_b16 v[46:47], v8 offset:35328
    s_waitcnt lgkmcnt(7)
    v_mfma_f32_32x32x16_bf16 v[80:95], v[24:27], v[16:19], v[80:95]
    v_mfma_f32_32x32x16_bf16 v[96:111], v[16:19], v[28:31], v[96:111]
    v_mfma_f32_32x32x16_bf16 v[64:79], v[20:23], v[16:19], v[64:79]
    s_waitcnt lgkmcnt(0)
    s_barrier
    ds_read_b128 v[16:19], v6 offset:8192
    ds_read_b64_tr_b16 v[20:21], v8 offset:36864
    ds_read_b64_tr_b16 v[22:23], v8 offset:37376
    ds_read_b64_tr_b16 v[24:25], v8 offset:40960
    ds_read_b64_tr_b16 v[26:27], v8 offset:41472
    ds_read_b64_tr_b16 v[28:29], v8 offset:45056
    ds_read_b64_tr_b16 v[30:31], v8 offset:45568
    v_mfma_f32_32x32x16_bf16 v[80:95], v[40:43], v[32:35], v[80:95]
    v_mfma_f32_32x32x16_bf16 v[96:111], v[32:35], v[44:47], v[96:111]
    v_mfma_f32_32x32x16_bf16 v[64:79], v[36:39], v[32:35], v[64:79]
    ds_read_b128 v[32:35], v7 offset:8192
    ds_read_b64_tr_b16 v[36:37], v8 offset:38912
    ds_read_b64_tr_b16 v[38:39], v8 offset:39424
    ds_read_b64_tr_b16 v[40:41], v8 offset:43008
    ds_read_b64_tr_b16 v[42:43], v8 offset:43520
    ds_read_b64_tr_b16 v[44:45], v8 offset:47104
    ds_read_b64_tr_b16 v[46:47], v8 offset:47616
    s_waitcnt lgkmcnt(7)
    v_mfma_f32_32x32x16_bf16 v[80:95], v[24:27], v[16:19], v[80:95]
    v_mfma_f32_32x32x16_bf16 v[96:111], v[16:19], v[28:31], v[96:111]
    v_mfma_f32_32x32x16_bf16 v[64:79], v[20:23], v[16:19], v[64:79]
    s_waitcnt lgkmcnt(0)
    s_barrier
    ds_read_b128 v[16:19], v4 offset:16384
    ds_read_b64_tr_b16 v[20:21], v8 offset:0
    ds_read_b64_tr_b16 v[22:23], v8 offset:512
    ds_read_b64_tr_b16 v[24:25], v8 offset:4096
    ds_read_b64_tr_b16 v[26:27], v8 offset:4608
    ds_read_b64_tr_b16 v[28:29], v8 offset:8192
    ds_read_b64_tr_b16 v[30:31], v8 offset:8704
    v_mfma_f32_32x32x16_bf16 v[80:95], v[40:43], v[32:35], v[80:95]
    v_mfma_f32_32x32x16_bf16 v[96:111], v[32:35], v[44:47], v[96:111]
    v_mfma_f32_32x32x16_bf16 v[64:79], v[36:39], v[32:35], v[64:79]
    ds_read_b128 v[32:35], v5 offset:16384
    ds_read_b64_tr_b16 v[36:37], v8 offset:2048
    ds_read_b64_tr_b16 v[38:39], v8 offset:2560
    ds_read_b64_tr_b16 v[40:41], v8 offset:6144
    ds_read_b64_tr_b16 v[42:43], v8 offset:6656
    ds_read_b64_tr_b16 v[44:45], v8 offset:10240
    ds_read_b64_tr_b16 v[46:47], v8 offset:10752
    s_waitcnt lgkmcnt(7)
    v_mfma_f32_32x32x16_bf16 v[80:95], v[24:27], v[16:19], v[80:95]
    v_mfma_f32_32x32x16_bf16 v[96:111], v[16:19], v[28:31], v[96:111]
    v_mfma_f32_32x32x16_bf16 v[64:79], v[20:23], v[16:19], v[64:79]
    s_waitcnt lgkmcnt(0)
    s_barrier
    ds_read_b128 v[16:19], v6 offset:16384
    ds_read_b64_tr_b16 v[20:21], v8 offset:12288
    ds_read_b64_tr_b16 v[22:23], v8 offset:12800
    ds_read_b64_tr_b16 v[24:25], v8 offset:16384
    ds_read_b64_tr_b16 v[26:27], v8 offset:16896
    ds_read_b64_tr_b16 v[28:29], v8 offset:20480
    ds_read_b64_tr_b16 v[30:31], v8 offset:20992
    v_mfma_f32_32x32x16_bf16 v[80:95], v[40:43], v[32:35], v[80:95]
    v_mfma_f32_32x32x16_bf16 v[96:111], v[32:35], v[44:47], v[96:111]
    v_mfma_f32_32x32x16_bf16 v[64:79], v[36:39], v[32:35], v[64:79]
    ds_read_b128 v[32:35], v7 offset:16384
    ds_read_b64_tr_b16 v[36:37], v8 offset:14336
    ds_read_b64_tr_b16 v[38:39], v8 offset:14848
    ds_read_b64_tr_b16 v[40:41], v8 offset:18432
    ds_read_b64_tr_b16 v[42:43], v8 offset:18944
    ds_read_b64_tr_b16 v[44:45], v8 offset:22528
    ds_read_b64_tr_b16 v[46:47], v8 offset:23040
    s_waitcnt lgkmcnt(7)
    v_mfma_f32_32x32x16_bf16 v[80:95], v[24:27], v[16:19], v[80:95]
    v_mfma_f32_32x32x16_bf16 v[96:111], v[16:19], v[28:31], v[96:111]
    v_mfma_f32_32x32x16_bf16 v[64:79], v[20:23], v[16:19], v[64:79]
    s_waitcnt lgkmcnt(0)
    s_barrier
    ds_read_b128 v[16:19], v4 offset:24576
    ds_read_b64_tr_b16 v[20:21], v8 offset:24576
    ds_read_b64_tr_b16 v[22:23], v8 offset:25088
    ds_read_b64_tr_b16 v[24:25], v8 offset:28672
    ds_read_b64_tr_b16 v[26:27], v8 offset:29184
    ds_read_b64_tr_b16 v[28:29], v8 offset:32768
    ds_read_b64_tr_b16 v[30:31], v8 offset:33280
    v_mfma_f32_32x32x16_bf16 v[80:95], v[40:43], v[32:35], v[80:95]
    v_mfma_f32_32x32x16_bf16 v[96:111], v[32:35], v[44:47], v[96:111]
    v_mfma_f32_32x32x16_bf16 v[64:79], v[36:39], v[32:35], v[64:79]
    ds_read_b128 v[32:35], v5 offset:24576
    ds_read_b64_tr_b16 v[36:37], v8 offset:26624
    ds_read_b64_tr_b16 v[38:39], v8 offset:27136
    ds_read_b64_tr_b16 v[40:41], v8 offset:30720
    ds_read_b64_tr_b16 v[42:43], v8 offset:31232
    ds_read_b64_tr_b16 v[44:45], v8 offset:34816
    ds_read_b64_tr_b16 v[46:47], v8 offset:35328
    s_waitcnt lgkmcnt(7)
    v_mfma_f32_32x32x16_bf16 v[80:95], v[24:27], v[16:19], v[80:95]
    v_mfma_f32_32x32x16_bf16 v[96:111], v[16:19], v[28:31], v[96:111]
    v_mfma_f32_32x32x16_bf16 v[64:79], v[20:23], v[16:19], v[64:79]
    s_waitcnt lgkmcnt(0)
    s_barrier
    ds_read_b128 v[16:19], v6 offset:24576
    ds_read_b64_tr_b16 v[20:21], v8 offset:36864
    ds_read_b64_tr_b16 v[22:23], v8 offset:37376
    ds_read_b64_tr_b16 v[24:25], v8 offset:40960
    ds_read_b64_tr_b16 v[26:27], v8 offset:41472
    ds_read_b64_tr_b16 v[28:29], v8 offset:45056
    ds_read_b64_tr_b16 v[30:31], v8 offset:45568
    v_mfma_f32_32x32x16_bf16 v[80:95], v[40:43], v[32:35], v[80:95]
    v_mfma_f32_32x32x16_bf16 v[96:111], v[32:35], v[44:47], v[96:111]
    v_mfma_f32_32x32x16_bf16 v[64:79], v[36:39], v[32:35], v[64:79]
    ds_read_b128 v[32:35], v7 offset:24576
    ds_read_b64_tr_b16 v[36:37], v8 offset:38912
    ds_read_b64_tr_b16 v[38:39], v8 offset:39424
    ds_read_b64_tr_b16 v[40:41], v8 offset:43008
    ds_read_b64_tr_b16 v[42:43], v8 offset:43520
    ds_read_b64_tr_b16 v[44:45], v8 offset:47104
    ds_read_b64_tr_b16 v[46:47], v8 offset:47616
    s_waitcnt lgkmcnt(7)
    v_mfma_f32_32x32x16_bf16 v[80:95], v[24:27], v[16:19], v[80:95]
    v_mfma_f32_32x32x16_bf16 v[96:111], v[16:19], v[28:31], v[96:111]
    v_mfma_f32_32x32x16_bf16 v[64:79], v[20:23], v[16:19], v[64:79]
    s_waitcnt lgkmcnt(0)
    s_barrier
    ds_read_b128 v[16:19], v4 offset:0
    ds_read_b64_tr_b16 v[20:21], v8 offset:0
    ds_read_b64_tr_b16 v[22:23], v8 offset:512
    ds_read_b64_tr_b16 v[24:25], v8 offset:4096
    ds_read_b64_tr_b16 v[26:27], v8 offset:4608
    ds_read_b64_tr_b16 v[28:29], v8 offset:8192
    ds_read_b64_tr_b16 v[30:31], v8 offset:8704
    v_mfma_f32_32x32x16_bf16 v[80:95], v[40:43], v[32:35], v[80:95]
    v_mfma_f32_32x32x16_bf16 v[96:111], v[32:35], v[44:47], v[96:111]
    v_mfma_f32_32x32x16_bf16 v[64:79], v[36:39], v[32:35], v[64:79]
    ds_read_b128 v[32:35], v5 offset:0
    ds_read_b64_tr_b16 v[36:37], v8 offset:2048
    ds_read_b64_tr_b16 v[38:39], v8 offset:2560
    ds_read_b64_tr_b16 v[40:41], v8 offset:6144
    ds_read_b64_tr_b16 v[42:43], v8 offset:6656
    ds_read_b64_tr_b16 v[44:45], v8 offset:10240
    ds_read_b64_tr_b16 v[46:47], v8 offset:10752
    s_waitcnt lgkmcnt(7)
    v_mfma_f32_32x32x16_bf16 v[80:95], v[24:27], v[16:19], v[80:95]
    v_mfma_f32_32x32x16_bf16 v[96:111], v[16:19], v[28:31], v[96:111]
    v_mfma_f32_32x32x16_bf16 v[64:79], v[20:23], v[16:19], v[64:79]
    s_waitcnt lgkmcnt(0)
    s_barrier
    ds_read_b128 v[16:19], v6 offset:0
    ds_read_b64_tr_b16 v[20:21], v8 offset:12288
    ds_read_b64_tr_b16 v[22:23], v8 offset:12800
    ds_read_b64_tr_b16 v[24:25], v8 offset:16384
    ds_read_b64_tr_b16 v[26:27], v8 offset:16896
    ds_read_b64_tr_b16 v[28:29], v8 offset:20480
    ds_read_b64_tr_b16 v[30:31], v8 offset:20992
    v_mfma_f32_32x32x16_bf16 v[80:95], v[40:43], v[32:35], v[80:95]
    v_mfma_f32_32x32x16_bf16 v[96:111], v[32:35], v[44:47], v[96:111]
    v_mfma_f32_32x32x16_bf16 v[64:79], v[36:39], v[32:35], v[64:79]
    ds_read_b128 v[32:35], v7 offset:0
    ds_read_b64_tr_b16 v[36:37], v8 offset:14336
    ds_read_b64_tr_b16 v[38:39], v8 offset:14848
    ds_read_b64_tr_b16 v[40:41], v8 offset:18432
    ds_read_b64_tr_b16 v[42:43], v8 offset:18944
    ds_read_b64_tr_b16 v[44:45], v8 offset:22528
    ds_read_b64_tr_b16 v[46:47], v8 offset:23040
    s_waitcnt lgkmcnt(7)
    v_mfma_f32_32x32x16_bf16 v[80:95], v[24:27], v[16:19], v[80:95]
    v_mfma_f32_32x32x16_bf16 v[96:111], v[16:19], v[28:31], v[96:111]
    v_mfma_f32_32x32x16_bf16 v[64:79], v[20:23], v[16:19], v[64:79]
    s_waitcnt lgkmcnt(0)
    s_barrier
    ds_read_b128 v[16:19], v4 offset:8192
    ds_read_b64_tr_b16 v[20:21], v8 offset:24576
    ds_read_b64_tr_b16 v[22:23], v8 offset:25088
    ds_read_b64_tr_b16 v[24:25], v8 offset:28672
    ds_read_b64_tr_b16 v[26:27], v8 offset:29184
    ds_read_b64_tr_b16 v[28:29], v8 offset:32768
    ds_read_b64_tr_b16 v[30:31], v8 offset:33280
    v_mfma_f32_32x32x16_bf16 v[80:95], v[40:43], v[32:35], v[80:95]
    v_mfma_f32_32x32x16_bf16 v[96:111], v[32:35], v[44:47], v[96:111]
    v_mfma_f32_32x32x16_bf16 v[64:79], v[36:39], v[32:35], v[64:79]
    ds_read_b128 v[32:35], v5 offset:8192
    ds_read_b64_tr_b16 v[36:37], v8 offset:26624
    ds_read_b64_tr_b16 v[38:39], v8 offset:27136
    ds_read_b64_tr_b16 v[40:41], v8 offset:30720
    ds_read_b64_tr_b16 v[42:43], v8 offset:31232
    ds_read_b64_tr_b16 v[44:45], v8 offset:34816
    ds_read_b64_tr_b16 v[46:47], v8 offset:35328
    s_waitcnt lgkmcnt(7)
    v_mfma_f32_32x32x16_bf16 v[80:95], v[24:27], v[16:19], v[80:95]
    v_mfma_f32_32x32x16_bf16 v[96:111], v[16:19], v[28:31], v[96:111]
    v_mfma_f32_32x32x16_bf16 v[64:79], v[20:23], v[16:19], v[64:79]
    s_waitcnt lgkmcnt(0)
    s_barrier
    ds_read_b128 v[16:19], v6 offset:8192
    ds_read_b64_tr_b16 v[20:21], v8 offset:36864
    ds_read_b64_tr_b16 v[22:23], v8 offset:37376
    ds_read_b64_tr_b16 v[24:25], v8 offset:40960
    ds_read_b64_tr_b16 v[26:27], v8 offset:41472
    ds_read_b64_tr_b16 v[28:29], v8 offset:45056
    ds_read_b64_tr_b16 v[30:31], v8 offset:45568
    v_mfma_f32_32x32x16_bf16 v[80:95], v[40:43], v[32:35], v[80:95]
    v_mfma_f32_32x32x16_bf16 v[96:111], v[32:35], v[44:47], v[96:111]
    v_mfma_f32_32x32x16_bf16 v[64:79], v[36:39], v[32:35], v[64:79]
    ds_read_b128 v[32:35], v7 offset:8192
    ds_read_b64_tr_b16 v[36:37], v8 offset:38912
    ds_read_b64_tr_b16 v[38:39], v8 offset:39424
    ds_read_b64_tr_b16 v[40:41], v8 offset:43008
    ds_read_b64_tr_b16 v[42:43], v8 offset:43520
    ds_read_b64_tr_b16 v[44:45], v8 offset:47104
    ds_read_b64_tr_b16 v[46:47], v8 offset:47616
    s_waitcnt lgkmcnt(7)
    v_mfma_f32_32x32x16_bf16 v[80:95], v[24:27], v[16:19], v[80:95]
    v_mfma_f32_32x32x16_bf16 v[96:111], v[16:19], v[28:31], v[96:111]
    v_mfma_f32_32x32x16_bf16 v[64:79], v[20:23], v[16:19], v[64:79]
    s_waitcnt lgkmcnt(0)
    s_barrier
    ds_read_b128 v[16:19], v4 offset:16384
    ds_read_b64_tr_b16 v[20:21], v8 offset:0
    ds_read_b64_tr_b16 v[22:23], v8 offset:512
    ds_read_b64_tr_b16 v[24:25], v8 offset:4096
    ds_read_b64_tr_b16 v[26:27], v8 offset:4608
    ds_read_b64_tr_b16 v[28:29], v8 offset:8192
    ds_read_b64_tr_b16 v[30:31], v8 offset:8704
    v_mfma_f32_32x32x16_bf16 v[80:95], v[40:43], v[32:35], v[80:95]
    v_mfma_f32_32x32x16_bf16 v[96:111], v[32:35], v[44:47], v[96:111]
    v_mfma_f32_32x32x16_bf16 v[64:79], v[36:39], v[32:35], v[64:79]
    ds_read_b128 v[32:35], v5 offset:16384
    ds_read_b64_tr_b16 v[36:37], v8 offset:2048
    ds_read_b64_tr_b16 v[38:39], v8 offset:2560
    ds_read_b64_tr_b16 v[40:41], v8 offset:6144
    ds_read_b64_tr_b16 v[42:43], v8 offset:6656
    ds_read_b64_tr_b16 v[44:45], v8 offset:10240
    ds_read_b64_tr_b16 v[46:47], v8 offset:10752
    s_waitcnt lgkmcnt(7)
    v_mfma_f32_32x32x16_bf16 v[80:95], v[24:27], v[16:19], v[80:95]
    v_mfma_f32_32x32x16_bf16 v[96:111], v[16:19], v[28:31], v[96:111]
    v_mfma_f32_32x32x16_bf16 v[64:79], v[20:23], v[16:19], v[64:79]
    s_waitcnt lgkmcnt(0)
    s_barrier
    ds_read_b128 v[16:19], v6 offset:16384
    ds_read_b64_tr_b16 v[20:21], v8 offset:12288
    ds_read_b64_tr_b16 v[22:23], v8 offset:12800
    ds_read_b64_tr_b16 v[24:25], v8 offset:16384
    ds_read_b64_tr_b16 v[26:27], v8 offset:16896
    ds_read_b64_tr_b16 v[28:29], v8 offset:20480
    ds_read_b64_tr_b16 v[30:31], v8 offset:20992
    v_mfma_f32_32x32x16_bf16 v[80:95], v[40:43], v[32:35], v[80:95]
    v_mfma_f32_32x32x16_bf16 v[96:111], v[32:35], v[44:47], v[96:111]
    v_mfma_f32_32x32x16_bf16 v[64:79], v[36:39], v[32:35], v[64:79]
    ds_read_b128 v[32:35], v7 offset:16384
    ds_read_b64_tr_b16 v[36:37], v8 offset:14336
    ds_read_b64_tr_b16 v[38:39], v8 offset:14848
    ds_read_b64_tr_b16 v[40:41], v8 offset:18432
    ds_read_b64_tr_b16 v[42:43], v8 offset:18944
    ds_read_b64_tr_b16 v[44:45], v8 offset:22528
    ds_read_b64_tr_b16 v[46:47], v8 offset:23040
    s_waitcnt lgkmcnt(7)
    v_mfma_f32_32x32x16_bf16 v[80:95], v[24:27], v[16:19], v[80:95]
    v_mfma_f32_32x32x16_bf16 v[96:111], v[16:19], v[28:31], v[96:111]
    v_mfma_f32_32x32x16_bf16 v[64:79], v[20:23], v[16:19], v[64:79]
    s_waitcnt lgkmcnt(0)
    s_barrier
    ds_read_b128 v[16:19], v4 offset:24576
    ds_read_b64_tr_b16 v[20:21], v8 offset:24576
    ds_read_b64_tr_b16 v[22:23], v8 offset:25088
    ds_read_b64_tr_b16 v[24:25], v8 offset:28672
    ds_read_b64_tr_b16 v[26:27], v8 offset:29184
    ds_read_b64_tr_b16 v[28:29], v8 offset:32768
    ds_read_b64_tr_b16 v[30:31], v8 offset:33280
    v_mfma_f32_32x32x16_bf16 v[80:95], v[40:43], v[32:35], v[80:95]
    v_mfma_f32_32x32x16_bf16 v[96:111], v[32:35], v[44:47], v[96:111]
    v_mfma_f32_32x32x16_bf16 v[64:79], v[36:39], v[32:35], v[64:79]
    ds_read_b128 v[32:35], v5 offset:24576
    ds_read_b64_tr_b16 v[36:37], v8 offset:26624
    ds_read_b64_tr_b16 v[38:39], v8 offset:27136
    ds_read_b64_tr_b16 v[40:41], v8 offset:30720
    ds_read_b64_tr_b16 v[42:43], v8 offset:31232
    ds_read_b64_tr_b16 v[44:45], v8 offset:34816
    ds_read_b64_tr_b16 v[46:47], v8 offset:35328
    s_waitcnt lgkmcnt(7)
    v_mfma_f32_32x32x16_bf16 v[80:95], v[24:27], v[16:19], v[80:95]
    v_mfma_f32_32x32x16_bf16 v[96:111], v[16:19], v[28:31], v[96:111]
    v_mfma_f32_32x32x16_bf16 v[64:79], v[20:23], v[16:19], v[64:79]
    s_waitcnt lgkmcnt(0)
    s_barrier
    ds_read_b128 v[16:19], v6 offset:24576
    ds_read_b64_tr_b16 v[20:21], v8 offset:36864
    ds_read_b64_tr_b16 v[22:23], v8 offset:37376
    ds_read_b64_tr_b16 v[24:25], v8 offset:40960
    ds_read_b64_tr_b16 v[26:27], v8 offset:41472
    ds_read_b64_tr_b16 v[28:29], v8 offset:45056
    ds_read_b64_tr_b16 v[30:31], v8 offset:45568
    v_mfma_f32_32x32x16_bf16 v[80:95], v[40:43], v[32:35], v[80:95]
    v_mfma_f32_32x32x16_bf16 v[96:111], v[32:35], v[44:47], v[96:111]
    v_mfma_f32_32x32x16_bf16 v[64:79], v[36:39], v[32:35], v[64:79]
    ds_read_b128 v[32:35], v7 offset:24576
    ds_read_b64_tr_b16 v[36:37], v8 offset:38912
    ds_read_b64_tr_b16 v[38:39], v8 offset:39424
    ds_read_b64_tr_b16 v[40:41], v8 offset:43008
    ds_read_b64_tr_b16 v[42:43], v8 offset:43520
    ds_read_b64_tr_b16 v[44:45], v8 offset:47104
    ds_read_b64_tr_b16 v[46:47], v8 offset:47616
    s_waitcnt lgkmcnt(7)
    v_mfma_f32_32x32x16_bf16 v[80:95], v[24:27], v[16:19], v[80:95]
    v_mfma_f32_32x32x16_bf16 v[96:111], v[16:19], v[28:31], v[96:111]
    v_mfma_f32_32x32x16_bf16 v[64:79], v[20:23], v[16:19], v[64:79]
    s_waitcnt lgkmcnt(0)
    v_mfma_f32_32x32x16_bf16 v[80:95], v[40:43], v[32:35], v[80:95]
    v_mfma_f32_32x32x16_bf16 v[96:111], v[32:35], v[44:47], v[96:111]
    v_mfma_f32_32x32x16_bf16 v[64:79], v[36:39], v[32:35], v[64:79]
    s_add_u32 s61, s60, 2097152
    s_add_u32 s62, s60, 4194304
    s_add_u32 s63, s61, 0x10000
    s_nop 7
    v_cvt_pk_bf16_f32 v48, v80, v81
    v_cvt_pk_bf16_f32 v49, v82, v83
    v_cvt_pk_bf16_f32 v50, v84, v85
    v_cvt_pk_bf16_f32 v51, v86, v87
    buffer_store_dwordx4 v[48:51], v12, s[12:15], s61 offen sc1
    v_cvt_pk_bf16_f32 v52, v88, v89
    v_cvt_pk_bf16_f32 v53, v90, v91
    v_cvt_pk_bf16_f32 v54, v92, v93
    v_cvt_pk_bf16_f32 v55, v94, v95
    buffer_store_dwordx4 v[52:55], v12, s[12:15], s63 offen sc1
    v_cvt_pk_bf16_f32 v56, v96, v97
    v_cvt_pk_bf16_f32 v57, v98, v99
    v_cvt_pk_bf16_f32 v58, v100, v101
    v_cvt_pk_bf16_f32 v59, v102, v103
    buffer_store_dwordx4 v[56:59], v13, s[12:15], s62 offen sc1
    v_cvt_pk_bf16_f32 v60, v104, v105
    v_cvt_pk_bf16_f32 v61, v106, v107
    v_cvt_pk_bf16_f32 v62, v108, v109
    v_cvt_pk_bf16_f32 v63, v110, v111
    buffer_store_dwordx4 v[60:63], v13, s[12:15], s62 offen offset:512 sc1
    s_add_u32 s63, s60, 0x10000
    v_pk_mul_f32 v[64:65], v[64:65], s[52:53] op_sel_hi:[1,0]
    v_pk_mul_f32 v[66:67], v[66:67], s[52:53] op_sel_hi:[1,0]
    v_pk_mul_f32 v[68:69], v[68:69], s[52:53] op_sel_hi:[1,0]
    v_pk_mul_f32 v[70:71], v[70:71], s[52:53] op_sel_hi:[1,0]
    v_pk_mul_f32 v[72:73], v[72:73], s[52:53] op_sel_hi:[1,0]
    v_pk_mul_f32 v[74:75], v[74:75], s[52:53] op_sel_hi:[1,0]
    v_pk_mul_f32 v[76:77], v[76:77], s[52:53] op_sel_hi:[1,0]
    v_pk_mul_f32 v[78:79], v[78:79], s[52:53] op_sel_hi:[1,0]
    v_cvt_pk_bf16_f32 v16, v64, v65
    v_cvt_pk_bf16_f32 v17, v66, v67
    v_cvt_pk_bf16_f32 v18, v68, v69
    v_cvt_pk_bf16_f32 v19, v70, v71
    buffer_store_dwordx4 v[16:19], v12, s[12:15], s60 offen sc1
    v_cvt_pk_bf16_f32 v20, v72, v73
    v_cvt_pk_bf16_f32 v21, v74, v75
    v_cvt_pk_bf16_f32 v22, v76, v77
    v_cvt_pk_bf16_f32 v23, v78, v79
    buffer_store_dwordx4 v[20:23], v12, s[12:15], s63 offen sc1
    s_branch kf_ax
kf_gate:
    s_load_dwordx2 s[28:29], s[0:1], 64
    s_mov_b32 s30, 1024
    s_mov_b32 s31, 0x00020000
    s_setprio 3
    s_lshl_b32 s38, s33, 2
    s_add_u32 s38, s38, s34
    s_sub_u32 s38, s38, 28
    s_lshl_b32 s39, s38, 3
    s_add_u32 s39, s39, s32
    s_lshl_b32 s40, s38, 12
    s_lshl_b32 s41, s32, 10
    s_add_u32 s40, s40, s41
    s_add_u32 s40, s40, 18874368
    s_mul_i32 s41, s38, 8320
    s_add_u32 s41, s41, 19398656
    v_lshlrev_b32 v4, 4, v1
    v_lshlrev_b32 v5, 7, v1
    v_mov_b32 v8, -1
    v_mov_b32 v9, -1
    v_mov_b32 v10, -1
    v_mov_b32 v11, -1
    s_sleep 0
    s_cmp_lt_u32 s32, 4
    s_waitcnt lgkmcnt(0)
    s_cbranch_scc0 kf_gr1
    buffer_store_dwordx4 v[8:11], v4, s[12:15], s40 offen sc1
kf_gr1:
    s_cmp_eq_u32 s32, 4
    s_cbranch_scc0 kf_gr2
    s_mov_b64 exec, 0xff
    s_add_u32 s42, s41, 4096
    buffer_store_dwordx4 v[8:11], v4, s[12:15], s42 offen sc1
    s_mov_b64 exec, -1
kf_gr2:
    s_lshl_b32 s42, s38, 13
    s_lshl_b32 s43, s32, 10
    s_add_u32 s42, s42, s43
    s_add_u32 s42, s42, 19922944
    buffer_store_dwordx4 v[8:11], v4, s[12:15], s42 offen sc1
    s_cmp_eq_u32 s32, 5
    s_cbranch_scc0 kf_gr3
    s_add_u32 s42, s41, 6144
    buffer_store_dwordx4 v[8:11], v4, s[12:15], s42 offen sc1
kf_gr3:
    s_lshl_b32 s40, s39, 13
    s_lshl_b32 s41, s32, 5
    s_lshl_b32 s43, s38, 12
    s_lshl_b32 s43, s43, 0
    s_add_u32 s41, s41, s43
    s_add_u32 s41, s41, 18877952
    s_add_u32 s42, s40, 4096
    s_lshl_b32 s43, s38, 2
    v_mov_b32 v5, 1
    v_mov_b32 v6, 0
    s_waitcnt vmcnt(0)
    s_barrier
    s_cmp_eq_u32 s32, 0
    s_cbranch_scc0 kf_g1
    s_mov_b64 exec, 1
    buffer_store_dword v5, v6, s[24:27], s43 offen sc1
    s_mov_b64 exec, -1
kf_g1:
    s_sleep 127
    s_sleep 73
    buffer_load_dwordx4 v[8:11], v4, s[28:31], 0 offen
    buffer_load_dwordx4 v[16:19], v4, s[16:19], s40 offen offset:0
    buffer_load_dwordx4 v[20:23], v4, s[16:19], s40 offen offset:1024
    buffer_load_dwordx4 v[24:27], v4, s[16:19], s40 offen offset:2048
    buffer_load_dwordx4 v[28:31], v4, s[16:19], s40 offen offset:3072
    buffer_load_dwordx4 v[32:35], v4, s[16:19], s42 offen offset:0
    buffer_load_dwordx4 v[36:39], v4, s[16:19], s42 offen offset:1024
    buffer_load_dwordx4 v[40:43], v4, s[16:19], s42 offen offset:2048
    buffer_load_dwordx4 v[44:47], v4, s[16:19], s42 offen offset:3072
    s_waitcnt vmcnt(0)
    v_dot2_f32_bf16 v48, v16, v8, 0
    v_dot2_f32_bf16 v49, v20, v8, 0
    v_dot2_f32_bf16 v50, v24, v8, 0
    v_dot2_f32_bf16 v51, v28, v8, 0
    v_dot2_f32_bf16 v52, v32, v8, 0
    v_dot2_f32_bf16 v53, v36, v8, 0
    v_dot2_f32_bf16 v54, v40, v8, 0
    v_dot2_f32_bf16 v55, v44, v8, 0
    v_dot2_f32_bf16 v48, v17, v9, v48
    v_dot2_f32_bf16 v49, v21, v9, v49
    v_dot2_f32_bf16 v50, v25, v9, v50
    v_dot2_f32_bf16 v51, v29, v9, v51
    v_dot2_f32_bf16 v52, v33, v9, v52
    v_dot2_f32_bf16 v53, v37, v9, v53
    v_dot2_f32_bf16 v54, v41, v9, v54
    v_dot2_f32_bf16 v55, v45, v9, v55
    v_dot2_f32_bf16 v48, v18, v10, v48
    v_dot2_f32_bf16 v49, v22, v10, v49
    v_dot2_f32_bf16 v50, v26, v10, v50
    v_dot2_f32_bf16 v51, v30, v10, v51
    v_dot2_f32_bf16 v52, v34, v10, v52
    v_dot2_f32_bf16 v53, v38, v10, v53
    v_dot2_f32_bf16 v54, v42, v10, v54
    v_dot2_f32_bf16 v55, v46, v10, v55
    v_dot2_f32_bf16 v48, v19, v11, v48
    v_dot2_f32_bf16 v49, v23, v11, v49
    v_dot2_f32_bf16 v50, v27, v11, v50
    v_dot2_f32_bf16 v51, v31, v11, v51
    v_dot2_f32_bf16 v52, v35, v11, v52
    v_dot2_f32_bf16 v53, v39, v11, v53
    v_dot2_f32_bf16 v54, v43, v11, v54
    v_dot2_f32_bf16 v55, v47, v11, v55
    s_nop 1
    v_add_f32_dpp v56, v48, v48 quad_perm:[1,0,3,2] row_mask:0xf bank_mask:0xf
    v_add_f32_dpp v57, v49, v49 quad_perm:[1,0,3,2] row_mask:0xf bank_mask:0xf
    v_add_f32_dpp v58, v50, v50 quad_perm:[1,0,3,2] row_mask:0xf bank_mask:0xf
    v_add_f32_dpp v59, v51, v51 quad_perm:[1,0,3,2] row_mask:0xf bank_mask:0xf
    v_add_f32_dpp v60, v52, v52 quad_perm:[1,0,3,2] row_mask:0xf bank_mask:0xf
    v_add_f32_dpp v61, v53, v53 quad_perm:[1,0,3,2] row_mask:0xf bank_mask:0xf
    v_add_f32_dpp v62, v54, v54 quad_perm:[1,0,3,2] row_mask:0xf bank_mask:0xf
    v_add_f32_dpp v63, v55, v55 quad_perm:[1,0,3,2] row_mask:0xf bank_mask:0xf
    v_mov_b32 v48, v56
    v_mov_b32 v49, v57
    v_mov_b32 v50, v58
    v_mov_b32 v51, v59
    v_mov_b32 v52, v60
    v_mov_b32 v53, v61
    v_mov_b32 v54, v62
    v_mov_b32 v55, v63
    s_nop 1
    v_add_f32_dpp v56, v48, v48 quad_perm:[2,3,0,1] row_mask:0xf bank_mask:0xf
    v_add_f32_dpp v57, v49, v49 quad_perm:[2,3,0,1] row_mask:0xf bank_mask:0xf
    v_add_f32_dpp v58, v50, v50 quad_perm:[2,3,0,1] row_mask:0xf bank_mask:0xf
    v_add_f32_dpp v59, v51, v51 quad_perm:[2,3,0,1] row_mask:0xf bank_mask:0xf
    v_add_f32_dpp v60, v52, v52 quad_perm:[2,3,0,1] row_mask:0xf bank_mask:0xf
    v_add_f32_dpp v61, v53, v53 quad_perm:[2,3,0,1] row_mask:0xf bank_mask:0xf
    v_add_f32_dpp v62, v54, v54 quad_perm:[2,3,0,1] row_mask:0xf bank_mask:0xf
    v_add_f32_dpp v63, v55, v55 quad_perm:[2,3,0,1] row_mask:0xf bank_mask:0xf
    v_mov_b32 v48, v56
    v_mov_b32 v49, v57
    v_mov_b32 v50, v58
    v_mov_b32 v51, v59
    v_mov_b32 v52, v60
    v_mov_b32 v53, v61
    v_mov_b32 v54, v62
    v_mov_b32 v55, v63
    s_nop 1
    v_add_f32_dpp v56, v48, v48 row_half_mirror row_mask:0xf bank_mask:0xf
    v_add_f32_dpp v57, v49, v49 row_half_mirror row_mask:0xf bank_mask:0xf
    v_add_f32_dpp v58, v50, v50 row_half_mirror row_mask:0xf bank_mask:0xf
    v_add_f32_dpp v59, v51, v51 row_half_mirror row_mask:0xf bank_mask:0xf
    v_add_f32_dpp v60, v52, v52 row_half_mirror row_mask:0xf bank_mask:0xf
    v_add_f32_dpp v61, v53, v53 row_half_mirror row_mask:0xf bank_mask:0xf
    v_add_f32_dpp v62, v54, v54 row_half_mirror row_mask:0xf bank_mask:0xf
    v_add_f32_dpp v63, v55, v55 row_half_mirror row_mask:0xf bank_mask:0xf
    v_mov_b32 v48, v56
    v_mov_b32 v49, v57
    v_mov_b32 v50, v58
    v_mov_b32 v51, v59
    v_mov_b32 v52, v60
    v_mov_b32 v53, v61
    v_mov_b32 v54, v62
    v_mov_b32 v55, v63
    s_nop 1
    v_add_f32_dpp v56, v48, v48 row_mirror row_mask:0xf bank_mask:0xf
    v_add_f32_dpp v57, v49, v49 row_mirror row_mask:0xf bank_mask:0xf
    v_add_f32_dpp v58, v50, v50 row_mirror row_mask:0xf bank_mask:0xf
    v_add_f32_dpp v59, v51, v51 row_mirror row_mask:0xf bank_mask:0xf
    v_add_f32_dpp v60, v52, v52 row_mirror row_mask:0xf bank_mask:0xf
    v_add_f32_dpp v61, v53, v53 row_mirror row_mask:0xf bank_mask:0xf
    v_add_f32_dpp v62, v54, v54 row_mirror row_mask:0xf bank_mask:0xf
    v_add_f32_dpp v63, v55, v55 row_mirror row_mask:0xf bank_mask:0xf
    v_mov_b32 v48, v56
    v_mov_b32 v49, v57
    v_mov_b32 v50, v58
    v_mov_b32 v51, v59
    v_mov_b32 v52, v60
    v_mov_b32 v53, v61
    v_mov_b32 v54, v62
    v_mov_b32 v55, v63
    s_nop 1
    v_readlane_b32 s44, v48, 0
    v_readlane_b32 s45, v48, 16
    v_readlane_b32 s46, v48, 32
    v_readlane_b32 s47, v48, 48
    s_nop 1
    v_mov_b32 v56, s44
    v_add_f32 v56, s45, v56
    v_add_f32 v56, s46, v56
    v_add_f32 v56, s47, v56
    v_readlane_b32 s44, v49, 0
    v_readlane_b32 s45, v49, 16
    v_readlane_b32 s46, v49, 32
    v_readlane_b32 s47, v49, 48
    s_nop 1
    v_mov_b32 v57, s44
    v_add_f32 v57, s45, v57
    v_add_f32 v57, s46, v57
    v_add_f32 v57, s47, v57
    v_readlane_b32 s44, v50, 0
    v_readlane_b32 s45, v50, 16
    v_readlane_b32 s46, v50, 32
    v_readlane_b32 s47, v50, 48
    s_nop 1
    v_mov_b32 v58, s44
    v_add_f32 v58, s45, v58
    v_add_f32 v58, s46, v58
    v_add_f32 v58, s47, v58
    v_readlane_b32 s44, v51, 0
    v_readlane_b32 s45, v51, 16
    v_readlane_b32 s46, v51, 32
    v_readlane_b32 s47, v51, 48
    s_nop 1
    v_mov_b32 v59, s44
    v_add_f32 v59, s45, v59
    v_add_f32 v59, s46, v59
    v_add_f32 v59, s47, v59
    v_readlane_b32 s44, v52, 0
    v_readlane_b32 s45, v52, 16
    v_readlane_b32 s46, v52, 32
    v_readlane_b32 s47, v52, 48
    s_nop 1
    v_mov_b32 v60, s44
    v_add_f32 v60, s45, v60
    v_add_f32 v60, s46, v60
    v_add_f32 v60, s47, v60
    v_readlane_b32 s44, v53, 0
    v_readlane_b32 s45, v53, 16
    v_readlane_b32 s46, v53, 32
    v_readlane_b32 s47, v53, 48
    s_nop 1
    v_mov_b32 v61, s44
    v_add_f32 v61, s45, v61
    v_add_f32 v61, s46, v61
    v_add_f32 v61, s47, v61
    v_readlane_b32 s44, v54, 0
    v_readlane_b32 s45, v54, 16
    v_readlane_b32 s46, v54, 32
    v_readlane_b32 s47, v54, 48
    s_nop 1
    v_mov_b32 v62, s44
    v_add_f32 v62, s45, v62
    v_add_f32 v62, s46, v62
    v_add_f32 v62, s47, v62
    v_readlane_b32 s44, v55, 0
    v_readlane_b32 s45, v55, 16
    v_readlane_b32 s46, v55, 32
    v_readlane_b32 s47, v55, 48
    s_nop 1
    v_mov_b32 v63, s44
    v_add_f32 v63, s45, v63
    v_add_f32 v63, s46, v63
    v_add_f32 v63, s47, v63
    v_mul_f32 v56, 0xbfb8aa3b, v56
    v_mul_f32 v57, 0xbfb8aa3b, v57
    v_mul_f32 v58, 0xbfb8aa3b, v58
    v_mul_f32 v59, 0xbfb8aa3b, v59
    v_mul_f32 v60, 0xbfb8aa3b, v60
    v_mul_f32 v61, 0xbfb8aa3b, v61
    v_mul_f32 v62, 0xbfb8aa3b, v62
    v_mul_f32 v63, 0xbfb8aa3b, v63
    v_exp_f32 v56, v56
    v_exp_f32 v57, v57
    v_exp_f32 v58, v58
    v_exp_f32 v59, v59
    v_exp_f32 v60, v60
    v_exp_f32 v61, v61
    v_exp_f32 v62, v62
    v_exp_f32 v63, v63
    v_add_f32 v56, 1.0, v56
    v_add_f32 v57, 1.0, v57
    v_add_f32 v58, 1.0, v58
    v_add_f32 v59, 1.0, v59
    v_add_f32 v60, 1.0, v60
    v_add_f32 v61, 1.0, v61
    v_add_f32 v62, 1.0, v62
    v_add_f32 v63, 1.0, v63
    v_rcp_f32 v56, v56
    v_rcp_f32 v57, v57
    v_rcp_f32 v58, v58
    v_rcp_f32 v59, v59
    v_rcp_f32 v60, v60
    v_rcp_f32 v61, v61
    v_rcp_f32 v62, v62
    v_rcp_f32 v63, v63
    v_mov_b32 v4, 0
    s_mov_b64 exec, 1
    buffer_store_dwordx4 v[56:59], v4, s[12:15], s41 offen sc1
    buffer_store_dwordx4 v[60:63], v4, s[12:15], s41 offen offset:16 sc1
    s_mov_b64 exec, -1
    s_mov_b32 s35, 7
    v_lshrrev_b32 v12, 2, v1
    v_lshlrev_b32 v12, 12, v12
    v_and_b32 v13, 3, v1
    v_lshl_add_u32 v12, v13, 7, v12
    s_and_b32 s44, s32, 3
    s_lshl_b32 s44, s44, 16
    s_lshr_b32 s46, s32, 2
    s_lshl_b32 s46, s46, 9
    s_lshl_b32 s45, s38, 18
    s_add_u32 s44, s44, s45
    s_add_u32 s44, s44, s46
    buffer_load_dword v13, v12, s[8:11], s44 offen offset:0
    s_waitcnt vmcnt(0)
    buffer_load_dword v13, v12, s[8:11], s44 offen offset:1024
    s_waitcnt vmcnt(0)
    buffer_load_dword v13, v12, s[8:11], s44 offen offset:2048
    s_waitcnt vmcnt(0)
    buffer_load_dword v13, v12, s[8:11], s44 offen offset:3072
    s_waitcnt vmcnt(0)
    s_mul_i32 s44, s38, 180224
    s_mul_i32 s45, s32, 22528
    s_add_u32 s44, s44, s45
    s_add_u32 s44, s44, 20971520
    v_lshlrev_b32 v5, 4, v1
    v_mov_b32 v8, -1
    v_mov_b32 v9, -1
    v_mov_b32 v10, -1
    v_mov_b32 v11, -1
    s_mov_b32 s45, 0
kf_rg:
    buffer_store_dwordx4 v[8:11], v5, s[12:15], s44 offen sc1
    buffer_store_dwordx4 v[8:11], v5, s[12:15], s44 offen offset:1024 sc1
    s_add_u32 s44, s44, 2048
    s_add_u32 s45, s45, 1
    s_waitcnt vmcnt(2)
    s_sleep 0
    s_cmp_lt_u32 s45, 11
    s_cbranch_scc1 kf_rg
    s_mul_i32 s44, s38, 8320
    s_add_u32 s44, s44, 19402752
    v_mov_b32 v5, 1
    s_waitcnt vmcnt(0)
    s_barrier
    s_cmp_eq_u32 s32, 0
    s_cbranch_scc0 kf_rg1
    s_mov_b64 exec, 1
    buffer_store_dword v5, v4, s[12:15], s44 offen sc1
    s_mov_b64 exec, -1
kf_rg1:
    s_sleep 100
    s_getpc_b64 s[28:29]
kf_pc2:
    s_mov_b32 s30, kf_end-kf_pc2
    v_lshlrev_b32 v127, 7, v0
    buffer_load_dword v127, v127, s[28:31], 0 offen
    s_cmp_ge_u32 s32, 4
    s_waitcnt vmcnt(0)
    s_cbranch_scc1 k2_pre
    s_cmp_eq_u32 s32, 3
    s_cbranch_scc0 kf_g2
    v_lshlrev_b32 v5, 2, v2
    s_mov_b64 exec, -1
    s_mov_b32 s53, 0
kf_grd:
    buffer_load_dword v10, v5, s[24:27], 0 offen sc1
    s_add_u32 s53, s53, 1
    s_waitcnt vmcnt(0)
    v_cmp_ne_u32 vcc, 1, v10
    s_cbranch_vccz kf_grd_done
    s_sleep 4
    s_cmp_lt_u32 s53, 131072
    s_cbranch_scc1 kf_grd
kf_grd_done:
    s_mov_b64 exec, -1
kf_g2:
    s_barrier
    s_barrier
    s_cmp_eq_u32 s32, 3
    s_cbranch_scc0 kf_g7
    s_mul_i32 s44, s38, 180224
    s_add_u32 s44, s44, 21004288
    v_lshlrev_b32 v5, 13, v1
    s_mov_b64 exec, 0x7f
    s_mov_b32 s53, 0
kf_gh1:
    buffer_load_dword v6, v5, s[12:15], s44 offen sc1
    s_add_u32 s53, s53, 1
    s_waitcnt vmcnt(0)
    v_cmp_ne_u32 vcc, -1, v6
    s_bcnt1_i32_b64 s45, vcc
    s_cmp_ge_u32 s45, 1
    s_cbranch_scc1 kf_gh2
    s_sleep 2
    s_cmp_lt_u32 s53, 0x20000
    s_cbranch_scc1 kf_gh1
kf_gh2:
    s_mov_b64 exec, -1
kf_g7:
    s_waitcnt vmcnt(0)
    s_barrier
    s_branch k2_out1
kf_exit:
    s_endpgm
kf_alx:
    s_lshl_b32 s40, s56, 16
    v_lshrrev_b32 v6, 3, v1
    v_and_b32 v4, 7, v1
    v_lshrrev_b32 v7, 4, v1
    v_xor_b32 v4, v4, v7
    v_lshlrev_b32 v4, 4, v4
    v_lshl_add_u32 v4, v6, 10, v4
    v_xor_b32 v5, 64, v4
    s_waitcnt lgkmcnt(0)
    s_add_u32 s53, s75, 1
    s_and_b32 s53, s53, 7
    s_mul_i32 s45, s53, 128
    s_add_u32 s45, s45, s40
    s_mov_b32 m0, 57344
    s_add_u32 s41, s45, 0
    buffer_load_dwordx4 v4, s[16:19], s41 offen lds
    s_mov_b32 m0, 58368
    s_add_u32 s41, s45, 8192
    buffer_load_dwordx4 v5, s[16:19], s41 offen lds
    s_mov_b32 m0, 59392
    s_add_u32 s41, s45, 16384
    buffer_load_dwordx4 v4, s[16:19], s41 offen lds
    s_mov_b32 m0, 60416
    s_add_u32 s41, s45, 24576
    buffer_load_dwordx4 v5, s[16:19], s41 offen lds
    s_mov_b32 m0, 61440
    s_add_u32 s41, s45, 32768
    buffer_load_dwordx4 v4, s[16:19], s41 offen lds
    s_mov_b32 m0, 62464
    s_add_u32 s41, s45, 40960
    buffer_load_dwordx4 v5, s[16:19], s41 offen lds
    s_mov_b32 m0, 63488
    s_add_u32 s41, s45, 49152
    buffer_load_dwordx4 v4, s[16:19], s41 offen lds
    s_mov_b32 m0, 64512
    s_add_u32 s41, s45, 57344
    buffer_load_dwordx4 v5, s[16:19], s41 offen lds
    s_add_u32 s53, s75, 2
    s_and_b32 s53, s53, 7
    s_mul_i32 s45, s53, 128
    s_add_u32 s45, s45, s40
    s_mov_b32 m0, 65536
    s_add_u32 s41, s45, 0
    buffer_load_dwordx4 v4, s[16:19], s41 offen lds
    s_mov_b32 m0, 66560
    s_add_u32 s41, s45, 8192
    buffer_load_dwordx4 v5, s[16:19], s41 offen lds
    s_mov_b32 m0, 67584
    s_add_u32 s41, s45, 16384
    buffer_load_dwordx4 v4, s[16:19], s41 offen lds
    s_mov_b32 m0, 68608
    s_add_u32 s41, s45, 24576
    buffer_load_dwordx4 v5, s[16:19], s41 offen lds
    s_waitcnt vmcnt(12)
    s_barrier
    s_mov_b32 m0, 69632
    s_add_u32 s41, s45, 32768
    buffer_load_dwordx4 v4, s[16:19], s41 offen lds
    s_mov_b32 m0, 70656
    s_add_u32 s41, s45, 40960
    buffer_load_dwordx4 v5, s[16:19], s41 offen lds
    s_mov_b32 m0, 71680
    s_add_u32 s41, s45, 49152
    buffer_load_dwordx4 v4, s[16:19], s41 offen lds
    s_mov_b32 m0, 72704
    s_add_u32 s41, s45, 57344
    buffer_load_dwordx4 v5, s[16:19], s41 offen lds
    s_barrier
    s_add_u32 s53, s75, 3
    s_and_b32 s53, s53, 7
    s_mul_i32 s45, s53, 128
    s_add_u32 s45, s45, s40
    s_mov_b32 m0, 73728
    s_add_u32 s41, s45, 0
    buffer_load_dwordx4 v4, s[16:19], s41 offen lds
    s_mov_b32 m0, 74752
    s_add_u32 s41, s45, 8192
    buffer_load_dwordx4 v5, s[16:19], s41 offen lds
    s_mov_b32 m0, 75776
    s_add_u32 s41, s45, 16384
    buffer_load_dwordx4 v4, s[16:19], s41 offen lds
    s_mov_b32 m0, 76800
    s_add_u32 s41, s45, 24576
    buffer_load_dwordx4 v5, s[16:19], s41 offen lds
    s_waitcnt vmcnt(12)
    s_barrier
    s_mov_b32 m0, 77824
    s_add_u32 s41, s45, 32768
    buffer_load_dwordx4 v4, s[16:19], s41 offen lds
    s_mov_b32 m0, 78848
    s_add_u32 s41, s45, 40960
    buffer_load_dwordx4 v5, s[16:19], s41 offen lds
    s_mov_b32 m0, 79872
    s_add_u32 s41, s45, 49152
    buffer_load_dwordx4 v4, s[16:19], s41 offen lds
    s_mov_b32 m0, 80896
    s_add_u32 s41, s45, 57344
    buffer_load_dwordx4 v5, s[16:19], s41 offen lds
    s_barrier
    s_add_u32 s53, s75, 4
    s_and_b32 s53, s53, 7
    s_mul_i32 s45, s53, 128
    s_add_u32 s45, s45, s40
    s_mov_b32 m0, 49152
    s_add_u32 s41, s45, 0
    buffer_load_dwordx4 v4, s[16:19], s41 offen lds
    s_mov_b32 m0, 50176
    s_add_u32 s41, s45, 8192
    buffer_load_dwordx4 v5, s[16:19], s41 offen lds
    s_mov_b32 m0, 51200
    s_add_u32 s41, s45, 16384
    buffer_load_dwordx4 v4, s[16:19], s41 offen lds
    s_mov_b32 m0, 52224
    s_add_u32 s41, s45, 24576
    buffer_load_dwordx4 v5, s[16:19], s41 offen lds
    s_waitcnt vmcnt(12)
    s_barrier
    s_mov_b32 m0, 53248
    s_add_u32 s41, s45, 32768
    buffer_load_dwordx4 v4, s[16:19], s41 offen lds
    s_mov_b32 m0, 54272
    s_add_u32 s41, s45, 40960
    buffer_load_dwordx4 v5, s[16:19], s41 offen lds
    s_mov_b32 m0, 55296
    s_add_u32 s41, s45, 49152
    buffer_load_dwordx4 v4, s[16:19], s41 offen lds
    s_mov_b32 m0, 56320
    s_add_u32 s41, s45, 57344
    buffer_load_dwordx4 v5, s[16:19], s41 offen lds
    s_barrier
    s_add_u32 s53, s75, 5
    s_and_b32 s53, s53, 7
    s_mul_i32 s45, s53, 128
    s_add_u32 s45, s45, s40
    s_mov_b32 m0, 57344
    s_add_u32 s41, s45, 0
    buffer_load_dwordx4 v4, s[16:19], s41 offen lds
    s_mov_b32 m0, 58368
    s_add_u32 s41, s45, 8192
    buffer_load_dwordx4 v5, s[16:19], s41 offen lds
    s_mov_b32 m0, 59392
    s_add_u32 s41, s45, 16384
    buffer_load_dwordx4 v4, s[16:19], s41 offen lds
    s_mov_b32 m0, 60416
    s_add_u32 s41, s45, 24576
    buffer_load_dwordx4 v5, s[16:19], s41 offen lds
    s_waitcnt vmcnt(12)
    s_barrier
    s_mov_b32 m0, 61440
    s_add_u32 s41, s45, 32768
    buffer_load_dwordx4 v4, s[16:19], s41 offen lds
    s_mov_b32 m0, 62464
    s_add_u32 s41, s45, 40960
    buffer_load_dwordx4 v5, s[16:19], s41 offen lds
    s_mov_b32 m0, 63488
    s_add_u32 s41, s45, 49152
    buffer_load_dwordx4 v4, s[16:19], s41 offen lds
    s_mov_b32 m0, 64512
    s_add_u32 s41, s45, 57344
    buffer_load_dwordx4 v5, s[16:19], s41 offen lds
    s_barrier
    s_add_u32 s53, s75, 6
    s_and_b32 s53, s53, 7
    s_mul_i32 s45, s53, 128
    s_add_u32 s45, s45, s40
    s_mov_b32 m0, 65536
    s_add_u32 s41, s45, 0
    buffer_load_dwordx4 v4, s[16:19], s41 offen lds
    s_mov_b32 m0, 66560
    s_add_u32 s41, s45, 8192
    buffer_load_dwordx4 v5, s[16:19], s41 offen lds
    s_mov_b32 m0, 67584
    s_add_u32 s41, s45, 16384
    buffer_load_dwordx4 v4, s[16:19], s41 offen lds
    s_mov_b32 m0, 68608
    s_add_u32 s41, s45, 24576
    buffer_load_dwordx4 v5, s[16:19], s41 offen lds
    s_waitcnt vmcnt(12)
    s_barrier
    s_mov_b32 m0, 69632
    s_add_u32 s41, s45, 32768
    buffer_load_dwordx4 v4, s[16:19], s41 offen lds
    s_mov_b32 m0, 70656
    s_add_u32 s41, s45, 40960
    buffer_load_dwordx4 v5, s[16:19], s41 offen lds
    s_mov_b32 m0, 71680
    s_add_u32 s41, s45, 49152
    buffer_load_dwordx4 v4, s[16:19], s41 offen lds
    s_mov_b32 m0, 72704
    s_add_u32 s41, s45, 57344
    buffer_load_dwordx4 v5, s[16:19], s41 offen lds
    s_barrier
    s_add_u32 s53, s75, 7
    s_and_b32 s53, s53, 7
    s_mul_i32 s45, s53, 128
    s_add_u32 s45, s45, s40
    s_mov_b32 m0, 73728
    s_add_u32 s41, s45, 0
    buffer_load_dwordx4 v4, s[16:19], s41 offen lds
    s_mov_b32 m0, 74752
    s_add_u32 s41, s45, 8192
    buffer_load_dwordx4 v5, s[16:19], s41 offen lds
    s_mov_b32 m0, 75776
    s_add_u32 s41, s45, 16384
    buffer_load_dwordx4 v4, s[16:19], s41 offen lds
    s_mov_b32 m0, 76800
    s_add_u32 s41, s45, 24576
    buffer_load_dwordx4 v5, s[16:19], s41 offen lds
    s_waitcnt vmcnt(12)
    s_barrier
    s_mov_b32 m0, 77824
    s_add_u32 s41, s45, 32768
    buffer_load_dwordx4 v4, s[16:19], s41 offen lds
    s_mov_b32 m0, 78848
    s_add_u32 s41, s45, 40960
    buffer_load_dwordx4 v5, s[16:19], s41 offen lds
    s_mov_b32 m0, 79872
    s_add_u32 s41, s45, 49152
    buffer_load_dwordx4 v4, s[16:19], s41 offen lds
    s_mov_b32 m0, 80896
    s_add_u32 s41, s45, 57344
    buffer_load_dwordx4 v5, s[16:19], s41 offen lds
    s_barrier
    s_waitcnt vmcnt(8)
    s_barrier
    s_barrier
    s_waitcnt vmcnt(0)
    s_barrier
    s_barrier
    v_lshlrev_b32 v112, 2, v2
    s_setprio 0
    s_mov_b64 exec, -1
    s_mov_b32 s53, 0
kf_ard:
    buffer_load_dword v10, v112, s[24:27], 0 offen sc1
    s_add_u32 s53, s53, 1
    s_waitcnt vmcnt(0)
    v_cmp_ne_u32 vcc, 1, v10
    s_cbranch_vccz kf_ard_done
    s_sleep 4
    s_cmp_lt_u32 s53, 131072
    s_cbranch_scc1 kf_ard
kf_ard_done:
    s_mov_b64 exec, -1
    s_waitcnt vmcnt(0)
kf_ax:
    s_lshr_b32 s44, s56, 3
    s_and_b32 s45, s56, 7
    v_bfe_u32 v120, v1, 1, 2
    v_sub_u32 v119, s44, v120
    v_and_b32 v119, 3, v119
    v_lshlrev_b32 v119, 2, v119
    v_lshl_add_u32 v119, v1, 10, v119
    s_lshl_b32 s45, s45, 7
    s_add_u32 s45, s45, 4
    v_add_u32 v119, s45, v119
    s_lshr_b32 s44, s56, 2
    s_lshl_b32 s44, s44, 3
    s_and_b32 s45, s56, 3
    s_add_u32 s44, s44, s45
    s_lshl_b32 s44, s44, 7
    v_lshlrev_b32 v120, 13, v120
    v_and_b32 v118, 1, v1
    v_lshl_add_u32 v120, v118, 9, v120
    v_add_u32 v120, s44, v120
    v_cmp_gt_u32 vcc, 32, v1
    v_mov_b32 v118, 1
    s_lshl_b32 s63, s57, 15
    v_cndmask_b32 v119, v120, v119, vcc
    s_add_u32 s63, s63, 19922944
    s_lshr_b32 s35, s34, 3
    s_lshl_b32 s44, s33, 2
    s_add_u32 s35, s35, s44
    s_lshl_b32 s39, s35, 16
    s_lshl_b32 s42, s32, 11
    s_add_u32 s40, s39, s42
    s_add_u32 s41, s40, 4194304
    s_add_u32 s40, s40, 2097152
    v_lshlrev_b32 v46, 4, v1
    s_and_b32 s38, s34, 7
    s_lshl_b32 s38, s38, 2
    s_and_b32 s44, s32, 3
    s_add_u32 s38, s38, s44
    s_lshl_b32 s38, s38, 1
    s_lshl_b32 s51, s38, 10
    s_add_u32 s51, s51, s39
    s_add_u32 s51, s51, 0
    s_lshr_b32 s48, s32, 2
    s_add_u32 s38, s38, s48
    s_mov_b32 s36, 0x0000ffff
    s_mov_b32 s37, 0x0000ffff
    s_lshr_b32 s61, s38, 1
    s_mul_i32 s61, s61, 8320
    s_add_u32 s61, s61, 19402752
    v_mov_b32 v114, 0
    v_mov_b32 v115, 0
    s_lshr_b32 s58, s38, 1
    s_lshl_b32 s58, s58, 12
    s_and_b32 s59, s38, 1
    s_lshl_b32 s59, s59, 7
    s_add_u32 s58, s58, s59
    s_add_u32 s58, s58, 18877952
    v_lshlrev_b32 v117, 2, v2
    s_lshl_b32 s44, s48, 13
    v_add_u32 v44, s44, v46
    v_and_b32 v113, 15, v2
    v_lshlrev_b32 v113, 4, v113
    v_lshl_add_u32 v45, v3, 8, v113
    s_add_u32 s44, s44, 16384
    v_add_u32 v45, s44, v45
    v_mov_b32 v20, 0
    v_mov_b32 v21, 0
    v_mov_b32 v22, 0
    v_mov_b32 v23, 0
    v_mov_b32 v24, 0
    v_mov_b32 v25, 0
    v_mov_b32 v26, 0
    v_mov_b32 v27, 0
    v_mov_b32 v28, 0
    v_mov_b32 v29, 0
    v_mov_b32 v30, 0
    v_mov_b32 v31, 0
    v_mov_b32 v32, 0
    v_mov_b32 v33, 0
    v_mov_b32 v34, 0
    v_mov_b32 v35, 0
    s_mov_b32 exec_lo, 0x00110000
    s_mov_b32 exec_hi, 0x00110000
    v_mov_b32 v20, 0x3f803f80
    v_mov_b32 v21, 0x3f803f80
    v_mov_b32 v22, 0x3f803f80
    v_mov_b32 v23, 0x3f803f80
    v_mov_b32 v24, 0x3f803f80
    v_mov_b32 v25, 0x3f803f80
    v_mov_b32 v26, 0x3f803f80
    v_mov_b32 v27, 0x3f803f80
    v_mov_b32 v28, 0x3f803f80
    v_mov_b32 v29, 0x3f803f80
    v_mov_b32 v30, 0x3f803f80
    v_mov_b32 v31, 0x3f803f80
    v_mov_b32 v32, 0x3f803f80
    v_mov_b32 v33, 0x3f803f80
    v_mov_b32 v34, 0x3f803f80
    v_mov_b32 v35, 0x3f803f80
    s_mov_b64 exec, -1
    v_mov_b32 v80, 0
    v_mov_b32 v81, 0
    v_mov_b32 v82, 0
    v_mov_b32 v83, 0
    v_mov_b32 v84, 0
    v_mov_b32 v85, 0
    v_mov_b32 v86, 0
    v_mov_b32 v87, 0
    v_mov_b32 v88, 0
    v_mov_b32 v89, 0
    v_mov_b32 v90, 0
    v_mov_b32 v91, 0
    v_mov_b32 v92, 0
    v_mov_b32 v93, 0
    v_mov_b32 v94, 0
    v_mov_b32 v95, 0
    v_mov_b32 v96, 0
    v_mov_b32 v97, 0
    v_mov_b32 v98, 0
    v_mov_b32 v99, 0
    v_mov_b32 v100, 0
    v_mov_b32 v101, 0
    v_mov_b32 v102, 0
    v_mov_b32 v103, 0
    v_mov_b32 v104, 0
    v_mov_b32 v105, 0
    v_mov_b32 v106, 0
    v_mov_b32 v107, 0
    v_mov_b32 v108, 0
    v_mov_b32 v109, 0
    v_mov_b32 v110, 0
    v_mov_b32 v111, 0
    v_mov_b32 v36, 0
    v_mov_b32 v37, 0
    v_mov_b32 v38, 0
    v_mov_b32 v39, 0
    v_mov_b32 v40, 0
    v_mov_b32 v41, 0
    v_mov_b32 v42, 0
    v_mov_b32 v43, 0
    s_mov_b32 s43, 0
    s_setprio 3
    s_bfe_u32 s44, s34, 0x20001
    s_lshl_b32 s47, s44, 14
    s_add_u32 s47, s47, s42
    s_add_u32 s62, s39, 2097152
    s_add_u32 s40, s47, s62
    s_add_u32 s41, s40, 2097152
    s_lshl_b32 s50, s33, 5
    s_add_u32 s50, s50, s34
    s_lshl_b32 s50, s50, 3
    s_add_u32 s50, s50, s32
    s_lshl_b32 s50, s50, 7
    s_add_u32 s50, s50, 19922944
    s_add_u32 s64, s12, s50
    s_addc_u32 s65, s13, 0
    s_mov_b32 s53, 0
    s_cmp_eq_u32 s32, 7
    s_waitcnt vmcnt(0)
    s_barrier
    s_cbranch_scc0 kf_ax1
    s_mov_b32 exec_hi, 0xff
    s_nop 0
    buffer_store_dword v118, v119, s[12:15], s63 offen sc1
    s_mov_b64 exec, -1
kf_ax1:
kf_ap1:
    s_load_dwordx2 s[72:73], s[64:65], 0 glc
    s_add_u32 s53, s53, 1
    s_waitcnt lgkmcnt(0)
    s_or_b32 s72, s72, s73
    s_cmp_eq_u32 s72, 1
    s_cbranch_scc1 kf_ap2
    s_sleep 2
    s_cmp_lt_u32 s53, 400
    s_cbranch_scc1 kf_ap1
kf_apf:
    v_lshlrev_b32 v112, 2, v2
    s_mov_b64 exec, 0x1f
    s_mov_b32 s53, 0
kf_apq:
    buffer_load_dword v113, v112, s[12:15], s50 offen sc1
    s_add_u32 s53, s53, 1
    s_waitcnt vmcnt(0)
    v_cmp_ne_u32 vcc, 1, v113
    s_cbranch_vccz kf_apq_done
    s_sleep 8
    s_cmp_lt_u32 s53, 131072
    s_cbranch_scc1 kf_apq
kf_apq_done:
    s_mov_b64 exec, -1
    s_cmp_eq_u32 s72, 0
    s_cbranch_scc1 kf_ap4
kf_ap2:
    s_mov_b32 m0, s42
    s_nop 0
    buffer_load_dwordx4 v46, s[12:15], s40 offen sc1 lds
    buffer_load_dwordx4 v46, s[12:15], s40 offen offset:1024 sc1 lds
    s_add_u32 m0, s42, 16384
    s_add_u32 s47, s47, 16384
    buffer_load_dwordx4 v46, s[12:15], s41 offen sc1 lds
    buffer_load_dwordx4 v46, s[12:15], s41 offen offset:1024 sc1 lds
    s_and_b32 s47, s47, 0xffff
    s_add_u32 s40, s47, s62
    s_add_u32 s41, s40, 2097152
    s_xor_b32 s42, s42, 32768
    buffer_load_dwordx4 v[4:7], v46, s[12:15], s51 offen sc1
    buffer_load_dwordx4 v[8:11], v46, s[12:15], s51 offen offset:1024 sc1
    s_load_dwordx4 s[68:71], s[64:65], 8 glc
    s_lshr_b32 s61, s38, 1
    s_mul_i32 s61, s61, 8320
    s_add_u32 s61, s61, 19402752
    s_mov_b32 s49, 1
    s_mov_b32 s53, 0
    s_waitcnt vmcnt(0) lgkmcnt(0)
    s_or_b32 s74, s68, s69
    s_or_b32 s74, s74, s70
    s_cmp_eq_u32 s74, 1
    s_cbranch_scc1 kf_ap4
    s_load_dwordx4 s[68:71], s[64:65], 8 glc
    s_branch kf_ap5
kf_ap4:
    s_mov_b32 m0, s42
    s_nop 0
    buffer_load_dwordx4 v46, s[12:15], s40 offen sc1 lds
    buffer_load_dwordx4 v46, s[12:15], s40 offen offset:1024 sc1 lds
    s_add_u32 m0, s42, 16384
    s_add_u32 s47, s47, 16384
    buffer_load_dwordx4 v46, s[12:15], s41 offen sc1 lds
    buffer_load_dwordx4 v46, s[12:15], s41 offen offset:1024 sc1 lds
    s_and_b32 s47, s47, 0xffff
    s_add_u32 s40, s47, s62
    s_add_u32 s41, s40, 2097152
    s_xor_b32 s42, s42, 32768
    s_mov_b32 s49, 0
    s_cmp_eq_u32 s72, 0
    s_cbranch_scc1 k2_dr13
kf_ap5:
    s_setprio 0
    s_barrier
    ds_read_b128 v[12:15], v44 offset:0
    s_mov_b64 exec, s[36:37]
    ds_read_b128 v[20:23], v45 offset:0
    ds_read_b128 v[24:27], v45 offset:512
    s_mov_b64 exec, -1
    s_waitcnt lgkmcnt(2)
    v_mfma_f32_32x32x16_bf16 v[48:63], v[12:15], v[4:7], -4.0
    s_nop 7
    s_nop 3
.p2align 3
k2_aloop:
    v_exp_f32 v48, v48
    v_exp_f32 v49, v49
    v_mfma_f32_32x32x16_bf16 v[96:111], v[32:35], v[40:43], v[96:111]
    v_exp_f32 v50, v50
    ds_read_b128 v[16:19], v44 offset:1024
    v_exp_f32 v51, v51
    v_cvt_pk_bf16_f32 v36, v48, v49
    v_exp_f32 v52, v52
    v_exp_f32 v53, v53
    v_cvt_pk_bf16_f32 v37, v50, v51
    v_exp_f32 v54, v54
    v_exp_f32 v55, v55
    v_mfma_f32_32x32x16_bf16 v[64:79], v[12:15], v[8:11], -4.0
    v_cvt_pk_bf16_f32 v38, v52, v53
    v_cvt_pk_bf16_f32 v39, v54, v55
    v_exp_f32 v56, v56
    v_exp_f32 v57, v57
    v_exp_f32 v58, v58
    s_waitcnt lgkmcnt(1)
    v_exp_f32 v59, v59
    v_cvt_pk_bf16_f32 v40, v56, v57
    v_mfma_f32_32x32x16_bf16 v[80:95], v[20:23], v[36:39], v[80:95]
    v_exp_f32 v60, v60
    v_exp_f32 v61, v61
    v_cvt_pk_bf16_f32 v41, v58, v59
    v_exp_f32 v62, v62
    v_exp_f32 v63, v63
    v_cvt_pk_bf16_f32 v42, v60, v61
    v_cvt_pk_bf16_f32 v43, v62, v63
    v_exp_f32 v64, v64
    v_exp_f32 v65, v65
    v_mfma_f32_32x32x16_bf16 v[80:95], v[24:27], v[40:43], v[80:95]
    v_exp_f32 v66, v66
    s_mov_b64 exec, s[36:37]
    ds_read_b128 v[28:31], v45 offset:1024
    ds_read_b128 v[32:35], v45 offset:1536
    s_mov_b64 exec, -1
    v_exp_f32 v67, v67
    v_cvt_pk_bf16_f32 v36, v64, v65
    v_exp_f32 v68, v68
    v_exp_f32 v69, v69
    v_cvt_pk_bf16_f32 v37, v66, v67
    v_exp_f32 v70, v70
    s_waitcnt lgkmcnt(2)
    v_exp_f32 v71, v71
    v_mfma_f32_32x32x16_bf16 v[48:63], v[16:19], v[4:7], -4.0
    v_cvt_pk_bf16_f32 v38, v68, v69
    v_cvt_pk_bf16_f32 v39, v70, v71
    v_exp_f32 v72, v72
    v_exp_f32 v73, v73
    v_exp_f32 v74, v74
    v_exp_f32 v75, v75
    v_cvt_pk_bf16_f32 v40, v72, v73
    v_mfma_f32_32x32x16_bf16 v[96:111], v[20:23], v[36:39], v[96:111]
    v_exp_f32 v76, v76
    v_exp_f32 v77, v77
    v_cvt_pk_bf16_f32 v41, v74, v75
    v_exp_f32 v78, v78
    v_exp_f32 v79, v79
    v_cvt_pk_bf16_f32 v42, v76, v77
    v_cvt_pk_bf16_f32 v43, v78, v79
    v_exp_f32 v48, v48
    v_exp_f32 v49, v49
    v_mfma_f32_32x32x16_bf16 v[96:111], v[24:27], v[40:43], v[96:111]
    v_exp_f32 v50, v50
    ds_read_b128 v[12:15], v44 offset:2048
    v_exp_f32 v51, v51
    v_cvt_pk_bf16_f32 v36, v48, v49
    v_exp_f32 v52, v52
    v_exp_f32 v53, v53
    v_cvt_pk_bf16_f32 v37, v50, v51
    v_exp_f32 v54, v54
    v_exp_f32 v55, v55
    v_mfma_f32_32x32x16_bf16 v[64:79], v[16:19], v[8:11], -4.0
    v_cvt_pk_bf16_f32 v38, v52, v53
    v_cvt_pk_bf16_f32 v39, v54, v55
    v_exp_f32 v56, v56
    v_exp_f32 v57, v57
    v_exp_f32 v58, v58
    s_waitcnt lgkmcnt(1)
    v_exp_f32 v59, v59
    v_cvt_pk_bf16_f32 v40, v56, v57
    v_mfma_f32_32x32x16_bf16 v[80:95], v[28:31], v[36:39], v[80:95]
    v_exp_f32 v60, v60
    v_exp_f32 v61, v61
    v_cvt_pk_bf16_f32 v41, v58, v59
    v_exp_f32 v62, v62
    v_exp_f32 v63, v63
    v_cvt_pk_bf16_f32 v42, v60, v61
    v_cvt_pk_bf16_f32 v43, v62, v63
    v_exp_f32 v64, v64
    v_exp_f32 v65, v65
    v_mfma_f32_32x32x16_bf16 v[80:95], v[32:35], v[40:43], v[80:95]
    v_exp_f32 v66, v66
    s_mov_b64 exec, s[36:37]
    ds_read_b128 v[20:23], v45 offset:2048
    ds_read_b128 v[24:27], v45 offset:2560
    s_mov_b64 exec, -1
    v_exp_f32 v67, v67
    v_cvt_pk_bf16_f32 v36, v64, v65
    v_exp_f32 v68, v68
    v_exp_f32 v69, v69
    v_cvt_pk_bf16_f32 v37, v66, v67
    v_exp_f32 v70, v70
    s_waitcnt lgkmcnt(2)
    v_exp_f32 v71, v71
    v_mfma_f32_32x32x16_bf16 v[48:63], v[12:15], v[4:7], -4.0
    v_cvt_pk_bf16_f32 v38, v68, v69
    v_cvt_pk_bf16_f32 v39, v70, v71
    v_exp_f32 v72, v72
    v_exp_f32 v73, v73
    v_exp_f32 v74, v74
    v_exp_f32 v75, v75
    v_cvt_pk_bf16_f32 v40, v72, v73
    v_mfma_f32_32x32x16_bf16 v[96:111], v[28:31], v[36:39], v[96:111]
    v_exp_f32 v76, v76
    v_exp_f32 v77, v77
    v_cvt_pk_bf16_f32 v41, v74, v75
    v_exp_f32 v78, v78
    v_exp_f32 v79, v79
    v_cvt_pk_bf16_f32 v42, v76, v77
    v_cvt_pk_bf16_f32 v43, v78, v79
    v_exp_f32 v48, v48
    v_exp_f32 v49, v49
    v_mfma_f32_32x32x16_bf16 v[96:111], v[32:35], v[40:43], v[96:111]
    v_exp_f32 v50, v50
    ds_read_b128 v[16:19], v44 offset:3072
    v_exp_f32 v51, v51
    v_cvt_pk_bf16_f32 v36, v48, v49
    v_exp_f32 v52, v52
    v_exp_f32 v53, v53
    v_cvt_pk_bf16_f32 v37, v50, v51
    v_exp_f32 v54, v54
    v_exp_f32 v55, v55
    v_mfma_f32_32x32x16_bf16 v[64:79], v[12:15], v[8:11], -4.0
    v_cvt_pk_bf16_f32 v38, v52, v53
    v_cvt_pk_bf16_f32 v39, v54, v55
    v_exp_f32 v56, v56
    v_exp_f32 v57, v57
    v_exp_f32 v58, v58
    s_waitcnt lgkmcnt(1)
    v_exp_f32 v59, v59
    v_cvt_pk_bf16_f32 v40, v56, v57
    v_mfma_f32_32x32x16_bf16 v[80:95], v[20:23], v[36:39], v[80:95]
    v_exp_f32 v60, v60
    v_exp_f32 v61, v61
    v_cvt_pk_bf16_f32 v41, v58, v59
    v_exp_f32 v62, v62
    v_exp_f32 v63, v63
    v_cvt_pk_bf16_f32 v42, v60, v61
    v_cvt_pk_bf16_f32 v43, v62, v63
    v_exp_f32 v64, v64
    v_exp_f32 v65, v65
    v_mfma_f32_32x32x16_bf16 v[80:95], v[24:27], v[40:43], v[80:95]
    v_exp_f32 v66, v66
    s_mov_b64 exec, s[36:37]
    ds_read_b128 v[28:31], v45 offset:3072
    ds_read_b128 v[32:35], v45 offset:3584
    s_mov_b64 exec, -1
    v_exp_f32 v67, v67
    v_cvt_pk_bf16_f32 v36, v64, v65
    v_exp_f32 v68, v68
    v_exp_f32 v69, v69
    v_cvt_pk_bf16_f32 v37, v66, v67
    v_exp_f32 v70, v70
    s_waitcnt lgkmcnt(2)
    v_exp_f32 v71, v71
    v_mfma_f32_32x32x16_bf16 v[48:63], v[16:19], v[4:7], -4.0
    v_cvt_pk_bf16_f32 v38, v68, v69
    v_cvt_pk_bf16_f32 v39, v70, v71
    v_exp_f32 v72, v72
    v_exp_f32 v73, v73
    v_exp_f32 v74, v74
    v_exp_f32 v75, v75
    v_cvt_pk_bf16_f32 v40, v72, v73
    v_mfma_f32_32x32x16_bf16 v[96:111], v[20:23], v[36:39], v[96:111]
    v_exp_f32 v76, v76
    v_exp_f32 v77, v77
    v_cvt_pk_bf16_f32 v41, v74, v75
    v_exp_f32 v78, v78
    v_exp_f32 v79, v79
    v_cvt_pk_bf16_f32 v42, v76, v77
    v_cvt_pk_bf16_f32 v43, v78, v79
    s_cmp_eq_u32 s49, 1
    s_cbranch_scc1 k2_dq5
k2_dr5:
    v_exp_f32 v48, v48
    v_exp_f32 v49, v49
    v_mfma_f32_32x32x16_bf16 v[96:111], v[24:27], v[40:43], v[96:111]
    v_exp_f32 v50, v50
    ds_read_b128 v[12:15], v44 offset:4096
    v_exp_f32 v51, v51
    v_cvt_pk_bf16_f32 v36, v48, v49
    v_exp_f32 v52, v52
    v_exp_f32 v53, v53
    v_cvt_pk_bf16_f32 v37, v50, v51
    v_exp_f32 v54, v54
    v_exp_f32 v55, v55
    v_mfma_f32_32x32x16_bf16 v[64:79], v[16:19], v[8:11], -4.0
    v_cvt_pk_bf16_f32 v38, v52, v53
    v_cvt_pk_bf16_f32 v39, v54, v55
    v_exp_f32 v56, v56
    v_exp_f32 v57, v57
    v_exp_f32 v58, v58
    s_waitcnt lgkmcnt(1)
    v_exp_f32 v59, v59
    v_cvt_pk_bf16_f32 v40, v56, v57
    v_mfma_f32_32x32x16_bf16 v[80:95], v[28:31], v[36:39], v[80:95]
    v_exp_f32 v60, v60
    v_exp_f32 v61, v61
    v_cvt_pk_bf16_f32 v41, v58, v59
    v_exp_f32 v62, v62
    v_exp_f32 v63, v63
    v_cvt_pk_bf16_f32 v42, v60, v61
    v_cvt_pk_bf16_f32 v43, v62, v63
    v_exp_f32 v64, v64
    v_exp_f32 v65, v65
    v_mfma_f32_32x32x16_bf16 v[80:95], v[32:35], v[40:43], v[80:95]
    v_exp_f32 v66, v66
    s_mov_b64 exec, s[36:37]
    ds_read_b128 v[20:23], v45 offset:4096
    ds_read_b128 v[24:27], v45 offset:4608
    s_mov_b64 exec, -1
    v_exp_f32 v67, v67
    v_cvt_pk_bf16_f32 v36, v64, v65
    v_exp_f32 v68, v68
    v_exp_f32 v69, v69
    v_cvt_pk_bf16_f32 v37, v66, v67
    v_exp_f32 v70, v70
    s_waitcnt lgkmcnt(2)
    v_exp_f32 v71, v71
    v_mfma_f32_32x32x16_bf16 v[48:63], v[12:15], v[4:7], -4.0
    v_cvt_pk_bf16_f32 v38, v68, v69
    v_cvt_pk_bf16_f32 v39, v70, v71
    v_exp_f32 v72, v72
    v_exp_f32 v73, v73
    v_exp_f32 v74, v74
    v_exp_f32 v75, v75
    v_cvt_pk_bf16_f32 v40, v72, v73
    v_mfma_f32_32x32x16_bf16 v[96:111], v[28:31], v[36:39], v[96:111]
    v_exp_f32 v76, v76
    v_exp_f32 v77, v77
    v_cvt_pk_bf16_f32 v41, v74, v75
    v_exp_f32 v78, v78
    v_exp_f32 v79, v79
    v_cvt_pk_bf16_f32 v42, v76, v77
    v_cvt_pk_bf16_f32 v43, v78, v79
    v_exp_f32 v48, v48
    v_exp_f32 v49, v49
    v_mfma_f32_32x32x16_bf16 v[96:111], v[32:35], v[40:43], v[96:111]
    v_exp_f32 v50, v50
    ds_read_b128 v[16:19], v44 offset:5120
    v_exp_f32 v51, v51
    v_cvt_pk_bf16_f32 v36, v48, v49
    v_exp_f32 v52, v52
    v_exp_f32 v53, v53
    v_cvt_pk_bf16_f32 v37, v50, v51
    v_exp_f32 v54, v54
    v_exp_f32 v55, v55
    v_mfma_f32_32x32x16_bf16 v[64:79], v[12:15], v[8:11], -4.0
    v_cvt_pk_bf16_f32 v38, v52, v53
    v_cvt_pk_bf16_f32 v39, v54, v55
    v_exp_f32 v56, v56
    v_exp_f32 v57, v57
    v_exp_f32 v58, v58
    s_waitcnt lgkmcnt(1)
    v_exp_f32 v59, v59
    v_cvt_pk_bf16_f32 v40, v56, v57
    v_mfma_f32_32x32x16_bf16 v[80:95], v[20:23], v[36:39], v[80:95]
    v_exp_f32 v60, v60
    v_exp_f32 v61, v61
    v_cvt_pk_bf16_f32 v41, v58, v59
    v_exp_f32 v62, v62
    v_exp_f32 v63, v63
    v_cvt_pk_bf16_f32 v42, v60, v61
    v_cvt_pk_bf16_f32 v43, v62, v63
    v_exp_f32 v64, v64
    v_exp_f32 v65, v65
    v_mfma_f32_32x32x16_bf16 v[80:95], v[24:27], v[40:43], v[80:95]
    v_exp_f32 v66, v66
    s_mov_b64 exec, s[36:37]
    ds_read_b128 v[28:31], v45 offset:5120
    ds_read_b128 v[32:35], v45 offset:5632
    s_mov_b64 exec, -1
    v_exp_f32 v67, v67
    v_cvt_pk_bf16_f32 v36, v64, v65
    v_exp_f32 v68, v68
    v_exp_f32 v69, v69
    v_cvt_pk_bf16_f32 v37, v66, v67
    v_exp_f32 v70, v70
    s_waitcnt lgkmcnt(2)
    v_exp_f32 v71, v71
    v_mfma_f32_32x32x16_bf16 v[48:63], v[16:19], v[4:7], -4.0
    v_cvt_pk_bf16_f32 v38, v68, v69
    v_cvt_pk_bf16_f32 v39, v70, v71
    v_exp_f32 v72, v72
    v_exp_f32 v73, v73
    v_exp_f32 v74, v74
    v_exp_f32 v75, v75
    v_cvt_pk_bf16_f32 v40, v72, v73
    v_mfma_f32_32x32x16_bf16 v[96:111], v[20:23], v[36:39], v[96:111]
    v_exp_f32 v76, v76
    v_exp_f32 v77, v77
    v_cvt_pk_bf16_f32 v41, v74, v75
    v_exp_f32 v78, v78
    v_exp_f32 v79, v79
    v_cvt_pk_bf16_f32 v42, v76, v77
    v_cvt_pk_bf16_f32 v43, v78, v79
    v_exp_f32 v48, v48
    v_exp_f32 v49, v49
    v_mfma_f32_32x32x16_bf16 v[96:111], v[24:27], v[40:43], v[96:111]
    v_exp_f32 v50, v50
    ds_read_b128 v[12:15], v44 offset:6144
    v_exp_f32 v51, v51
    v_cvt_pk_bf16_f32 v36, v48, v49
    v_exp_f32 v52, v52
    v_exp_f32 v53, v53
    v_cvt_pk_bf16_f32 v37, v50, v51
    v_exp_f32 v54, v54
    v_exp_f32 v55, v55
    v_mfma_f32_32x32x16_bf16 v[64:79], v[16:19], v[8:11], -4.0
    v_cvt_pk_bf16_f32 v38, v52, v53
    v_cvt_pk_bf16_f32 v39, v54, v55
    v_exp_f32 v56, v56
    v_exp_f32 v57, v57
    v_exp_f32 v58, v58
    s_waitcnt lgkmcnt(1)
    v_exp_f32 v59, v59
    v_cvt_pk_bf16_f32 v40, v56, v57
    v_mfma_f32_32x32x16_bf16 v[80:95], v[28:31], v[36:39], v[80:95]
    v_exp_f32 v60, v60
    v_exp_f32 v61, v61
    v_cvt_pk_bf16_f32 v41, v58, v59
    v_exp_f32 v62, v62
    v_exp_f32 v63, v63
    v_cvt_pk_bf16_f32 v42, v60, v61
    v_cvt_pk_bf16_f32 v43, v62, v63
    v_exp_f32 v64, v64
    v_exp_f32 v65, v65
    v_mfma_f32_32x32x16_bf16 v[80:95], v[32:35], v[40:43], v[80:95]
    v_exp_f32 v66, v66
    s_mov_b64 exec, s[36:37]
    ds_read_b128 v[20:23], v45 offset:6144
    ds_read_b128 v[24:27], v45 offset:6656
    s_mov_b64 exec, -1
    v_exp_f32 v67, v67
    v_cvt_pk_bf16_f32 v36, v64, v65
    v_exp_f32 v68, v68
    v_exp_f32 v69, v69
    v_cvt_pk_bf16_f32 v37, v66, v67
    v_exp_f32 v70, v70
    s_waitcnt lgkmcnt(2)
    v_exp_f32 v71, v71
    v_mfma_f32_32x32x16_bf16 v[48:63], v[12:15], v[4:7], -4.0
    v_cvt_pk_bf16_f32 v38, v68, v69
    v_cvt_pk_bf16_f32 v39, v70, v71
    v_exp_f32 v72, v72
    v_exp_f32 v73, v73
    v_exp_f32 v74, v74
    v_exp_f32 v75, v75
    v_cvt_pk_bf16_f32 v40, v72, v73
    v_mfma_f32_32x32x16_bf16 v[96:111], v[28:31], v[36:39], v[96:111]
    v_exp_f32 v76, v76
    v_exp_f32 v77, v77
    v_cvt_pk_bf16_f32 v41, v74, v75
    v_exp_f32 v78, v78
    v_exp_f32 v79, v79
    v_cvt_pk_bf16_f32 v42, v76, v77
    v_cvt_pk_bf16_f32 v43, v78, v79
    v_exp_f32 v48, v48
    v_exp_f32 v49, v49
    v_mfma_f32_32x32x16_bf16 v[96:111], v[32:35], v[40:43], v[96:111]
    v_exp_f32 v50, v50
    ds_read_b128 v[16:19], v44 offset:7168
    v_exp_f32 v51, v51
    v_cvt_pk_bf16_f32 v36, v48, v49
    v_exp_f32 v52, v52
    v_exp_f32 v53, v53
    v_cvt_pk_bf16_f32 v37, v50, v51
    v_exp_f32 v54, v54
    v_exp_f32 v55, v55
    v_mfma_f32_32x32x16_bf16 v[64:79], v[12:15], v[8:11], -4.0
    v_cvt_pk_bf16_f32 v38, v52, v53
    v_cvt_pk_bf16_f32 v39, v54, v55
    v_exp_f32 v56, v56
    v_exp_f32 v57, v57
    v_exp_f32 v58, v58
    s_waitcnt lgkmcnt(1)
    v_exp_f32 v59, v59
    v_cvt_pk_bf16_f32 v40, v56, v57
    v_mfma_f32_32x32x16_bf16 v[80:95], v[20:23], v[36:39], v[80:95]
    v_exp_f32 v60, v60
    v_exp_f32 v61, v61
    v_cvt_pk_bf16_f32 v41, v58, v59
    v_exp_f32 v62, v62
    v_exp_f32 v63, v63
    v_cvt_pk_bf16_f32 v42, v60, v61
    v_cvt_pk_bf16_f32 v43, v62, v63
    v_exp_f32 v64, v64
    v_exp_f32 v65, v65
    v_mfma_f32_32x32x16_bf16 v[80:95], v[24:27], v[40:43], v[80:95]
    v_exp_f32 v66, v66
    s_mov_b64 exec, s[36:37]
    ds_read_b128 v[28:31], v45 offset:7168
    ds_read_b128 v[32:35], v45 offset:7680
    s_mov_b64 exec, -1
    v_exp_f32 v67, v67
    v_cvt_pk_bf16_f32 v36, v64, v65
    v_exp_f32 v68, v68
    v_exp_f32 v69, v69
    v_cvt_pk_bf16_f32 v37, v66, v67
    v_exp_f32 v70, v70
    s_waitcnt lgkmcnt(2)
    v_exp_f32 v71, v71
    v_mfma_f32_32x32x16_bf16 v[48:63], v[16:19], v[4:7], -4.0
    v_cvt_pk_bf16_f32 v38, v68, v69
    v_cvt_pk_bf16_f32 v39, v70, v71
    v_exp_f32 v72, v72
    v_exp_f32 v73, v73
    v_exp_f32 v74, v74
    v_exp_f32 v75, v75
    v_cvt_pk_bf16_f32 v40, v72, v73
    v_mfma_f32_32x32x16_bf16 v[96:111], v[20:23], v[36:39], v[96:111]
    v_exp_f32 v76, v76
    v_exp_f32 v77, v77
    v_cvt_pk_bf16_f32 v41, v74, v75
    v_exp_f32 v78, v78
    v_exp_f32 v79, v79
    v_cvt_pk_bf16_f32 v42, v76, v77
    v_cvt_pk_bf16_f32 v43, v78, v79
    s_cmp_eq_u32 s49, 1
    s_cbranch_scc1 k2_dq13
k2_dr13:
    v_exp_f32 v48, v48
    v_exp_f32 v49, v49
    v_mfma_f32_32x32x16_bf16 v[96:111], v[24:27], v[40:43], v[96:111]
    v_exp_f32 v50, v50
    v_xor_b32 v44, 0x8000, v44
    s_waitcnt vmcnt(0) lgkmcnt(0)
    s_barrier
    ds_read_b128 v[12:15], v44 offset:0
    v_exp_f32 v51, v51
    v_cvt_pk_bf16_f32 v36, v48, v49
    v_exp_f32 v52, v52
    s_cmp_lt_u32 s43, 2
    s_cbranch_scc0 k2_anodma
    s_mov_b32 m0, s42
    s_nop 0
    buffer_load_dwordx4 v46, s[12:15], s40 offen sc1 lds
    buffer_load_dwordx4 v46, s[12:15], s40 offen offset:1024 sc1 lds
    s_add_u32 m0, s42, 16384
    s_add_u32 s47, s47, 16384
    buffer_load_dwordx4 v46, s[12:15], s41 offen sc1 lds
    buffer_load_dwordx4 v46, s[12:15], s41 offen offset:1024 sc1 lds
    s_and_b32 s47, s47, 0xffff
    s_add_u32 s40, s47, s62
    s_add_u32 s41, s40, 2097152
    s_xor_b32 s42, s42, 32768
    s_branch k2_anof
k2_anodma:
    s_cmp_eq_u32 s43, 2
    s_cbranch_scc0 k2_anof
    buffer_load_dword v114, v115, s[12:15], s61 offen sc1
    buffer_load_dword v116, v117, s[12:15], s58 offen sc1
k2_anof:
    v_xor_b32 v45, 0x8000, v45
    v_exp_f32 v53, v53
    v_cvt_pk_bf16_f32 v37, v50, v51
    v_exp_f32 v54, v54
    v_exp_f32 v55, v55
    v_mfma_f32_32x32x16_bf16 v[64:79], v[16:19], v[8:11], -4.0
    v_cvt_pk_bf16_f32 v38, v52, v53
    v_cvt_pk_bf16_f32 v39, v54, v55
    v_exp_f32 v56, v56
    v_exp_f32 v57, v57
    v_exp_f32 v58, v58
    v_exp_f32 v59, v59
    v_cvt_pk_bf16_f32 v40, v56, v57
    v_mfma_f32_32x32x16_bf16 v[80:95], v[28:31], v[36:39], v[80:95]
    v_exp_f32 v60, v60
    v_exp_f32 v61, v61
    v_cvt_pk_bf16_f32 v41, v58, v59
    v_exp_f32 v62, v62
    v_exp_f32 v63, v63
    v_cvt_pk_bf16_f32 v42, v60, v61
    v_cvt_pk_bf16_f32 v43, v62, v63
    v_exp_f32 v64, v64
    v_exp_f32 v65, v65
    v_mfma_f32_32x32x16_bf16 v[80:95], v[32:35], v[40:43], v[80:95]
    v_exp_f32 v66, v66
    s_mov_b64 exec, s[36:37]
    ds_read_b128 v[20:23], v45 offset:0
    ds_read_b128 v[24:27], v45 offset:512
    s_mov_b64 exec, -1
    v_exp_f32 v67, v67
    v_cvt_pk_bf16_f32 v36, v64, v65
    v_exp_f32 v68, v68
    v_exp_f32 v69, v69
    v_cvt_pk_bf16_f32 v37, v66, v67
    v_exp_f32 v70, v70
    s_waitcnt lgkmcnt(2)
    v_exp_f32 v71, v71
    v_mfma_f32_32x32x16_bf16 v[48:63], v[12:15], v[4:7], -4.0
    v_cvt_pk_bf16_f32 v38, v68, v69
    v_cvt_pk_bf16_f32 v39, v70, v71
    v_exp_f32 v72, v72
    v_exp_f32 v73, v73
    v_exp_f32 v74, v74
    v_exp_f32 v75, v75
    v_cvt_pk_bf16_f32 v40, v72, v73
    v_mfma_f32_32x32x16_bf16 v[96:111], v[28:31], v[36:39], v[96:111]
    v_exp_f32 v76, v76
    v_exp_f32 v77, v77
    v_cvt_pk_bf16_f32 v41, v74, v75
    v_exp_f32 v78, v78
    v_exp_f32 v79, v79
    v_cvt_pk_bf16_f32 v42, v76, v77
    v_cvt_pk_bf16_f32 v43, v78, v79
    s_add_u32 s43, s43, 1
    s_cmp_lt_u32 s43, 4
    s_cbranch_scc1 k2_aloop
    s_setprio 3
    v_mfma_f32_32x32x16_bf16 v[96:111], v[32:35], v[40:43], v[96:111]
    s_and_b32 s44, s32, 3
    s_lshl_b32 s44, s44, 1
    s_add_u32 s44, s44, s48
    s_mul_i32 s45, s44, 2304
    s_xor_b32 s44, s44, 1
    s_mul_i32 s44, s44, 2304
    v_add_u32 v44, s45, v46
    v_add_u32 v112, s44, v46
    v_lshlrev_b32 v113, 2, v1
    v_add_u32 v36, s45, v113
    v_add_u32 v113, s44, v113
    s_waitcnt lgkmcnt(0)
    s_nop 0
    s_cmp_eq_u32 s48, 0
    s_cbranch_scc1 k2_ax0
    ds_write_b128 v44, v[80:83]
    ds_write_b128 v44, v[84:87] offset:1024
    ds_write_b32 v36, v88 offset:2048
    s_nop 1
    v_mov_b32 v80, v96
    v_mov_b32 v81, v97
    v_mov_b32 v82, v98
    v_mov_b32 v83, v99
    v_mov_b32 v84, v100
    v_mov_b32 v85, v101
    v_mov_b32 v86, v102
    v_mov_b32 v87, v103
    v_mov_b32 v88, v104
    v_mov_b32 v4, v8
    v_mov_b32 v5, v9
    v_mov_b32 v6, v10
    v_mov_b32 v7, v11
    s_branch k2_ax1
k2_ax0:
    ds_write_b128 v44, v[96:99]
    ds_write_b128 v44, v[100:103] offset:1024
    ds_write_b32 v36, v104 offset:2048
k2_ax1:
    s_waitcnt lgkmcnt(0)
    s_barrier
    ds_read_b128 v[48:51], v112
    ds_read_b128 v[52:55], v112 offset:1024
    ds_read_b32 v56, v113 offset:2048
    s_waitcnt lgkmcnt(0)
    v_add_f32 v80, v80, v48
    v_add_f32 v81, v81, v49
    v_add_f32 v82, v82, v50
    v_add_f32 v83, v83, v51
    v_add_f32 v84, v84, v52
    v_add_f32 v85, v85, v53
    v_add_f32 v86, v86, v54
    v_add_f32 v87, v87, v55
    v_add_f32 v88, v88, v56
    v_add_f32_e64 v112, |v80|, |v81|
    v_add_f32_e64 v112, v112, |v82|
    v_add_f32_e64 v112, v112, |v83|
    v_add_f32_e64 v112, v112, |v84|
    v_add_f32_e64 v112, v112, |v85|
    v_add_f32_e64 v112, v112, |v86|
    v_add_f32_e64 v112, v112, |v87|
    v_cmp_gt_f32 vcc, 0x7f800000, v112
    s_mov_b64 s[46:47], vcc
    v_cmp_lt_f32 vcc, 0x2b800000, v88
    s_and_b64 s[46:47], s[46:47], vcc
    v_cmp_gt_f32 vcc, 0x53800000, v88
    s_and_b64 s[46:47], s[46:47], vcc
    s_cmp_eq_u64 s[46:47], -1
    s_cbranch_scc0 k2_afall
k2_aepi:
    v_rcp_f32 v112, v88
    s_mul_i32 s44, s38, 90112
    s_lshl_b32 s45, s35, 10
    s_mov_b32 s53, 0
k2_ag:
    v_cmp_eq_u32 vcc, -1, v116
    s_cbranch_vccnz k2_agf
k2_agr:
    v_mul_f32 v112, v112, v116
    v_mul_f32 v80, v80, v112
    v_mul_f32 v81, v81, v112
    v_mul_f32 v82, v82, v112
    v_mul_f32 v83, v83, v112
    v_mul_f32 v84, v84, v112
    v_mul_f32 v85, v85, v112
    v_mul_f32 v86, v86, v112
    v_mul_f32 v87, v87, v112
    s_add_u32 s44, s44, s45
    s_add_u32 s44, s44, 20971520
    v_cvt_pk_bf16_f32 v36, v80, v81
    v_cvt_pk_bf16_f32 v37, v82, v83
    v_cvt_pk_bf16_f32 v38, v84, v85
    v_cvt_pk_bf16_f32 v39, v86, v87
    v_cmp_ne_u32 vcc, 1, v114
    s_cbranch_vccz k2_arf_done
    s_mov_b64 exec, 1
    s_mov_b32 s53, 0
k2_arf:
    buffer_load_dword v10, v115, s[12:15], s61 offen sc1
    s_add_u32 s53, s53, 1
    s_waitcnt vmcnt(0)
    v_cmp_ne_u32 vcc, 1, v10
    s_cbranch_vccz k2_arf_done
    s_sleep 8
    s_cmp_lt_u32 s53, 131072
    s_cbranch_scc1 k2_arf
k2_arf_done:
    s_mov_b64 exec, -1
    buffer_store_dwordx4 v[36:39], v46, s[12:15], s44 offen sc1
    s_endpgm
k2_agf:
    s_add_u32 s53, s53, 1
    s_cmp_ge_u32 s53, 0x10000
    s_cbranch_scc1 k2_agr
    s_sleep 4
    buffer_load_dword v116, v117, s[12:15], s58 offen sc1
    s_waitcnt vmcnt(0)
    s_branch k2_ag
k2_afall:
    s_add_u32 s40, s39, 2097152
    s_add_u32 s41, s39, 4194304
    s_mov_b32 s43, 0
    v_mov_b32 v112, 0xff800000
    v_and_b32 v45, 0x1ff, v45
k2_af1:
    buffer_load_dwordx4 v[12:15], v46, s[12:15], s40 offen sc1
    s_add_u32 s40, s40, 1024
    s_waitcnt vmcnt(0)
    v_mfma_f32_32x32x16_bf16 v[48:63], v[12:15], v[4:7], 0
    s_nop 7
    s_nop 3
    v_max3_f32 v112, v112, v48, v49
    v_max3_f32 v112, v112, v50, v51
    v_max3_f32 v112, v112, v52, v53
    v_max3_f32 v112, v112, v54, v55
    v_max3_f32 v112, v112, v56, v57
    v_max3_f32 v112, v112, v58, v59
    v_max3_f32 v112, v112, v60, v61
    v_max3_f32 v112, v112, v62, v63
    s_add_u32 s43, s43, 1
    s_cmp_lt_u32 s43, 64
    s_cbranch_scc1 k2_af1
    v_mov_b32 v113, v112
    s_nop 1
    v_permlane32_swap_b32 v112, v113
    s_nop 1
    v_max_f32 v112, v112, v113
    v_sub_f32 v64, 0, v112
    v_sub_f32 v65, 0, v112
    v_sub_f32 v66, 0, v112
    v_sub_f32 v67, 0, v112
    v_sub_f32 v68, 0, v112
    v_sub_f32 v69, 0, v112
    v_sub_f32 v70, 0, v112
    v_sub_f32 v71, 0, v112
    v_sub_f32 v72, 0, v112
    v_sub_f32 v73, 0, v112
    v_sub_f32 v74, 0, v112
    v_sub_f32 v75, 0, v112
    v_sub_f32 v76, 0, v112
    v_sub_f32 v77, 0, v112
    v_sub_f32 v78, 0, v112
    v_sub_f32 v79, 0, v112
    v_mov_b32 v80, 0
    v_mov_b32 v81, 0
    v_mov_b32 v82, 0
    v_mov_b32 v83, 0
    v_mov_b32 v84, 0
    v_mov_b32 v85, 0
    v_mov_b32 v86, 0
    v_mov_b32 v87, 0
    v_mov_b32 v88, 0
    v_mov_b32 v89, 0
    v_mov_b32 v90, 0
    v_mov_b32 v91, 0
    v_mov_b32 v92, 0
    v_mov_b32 v93, 0
    v_mov_b32 v94, 0
    v_mov_b32 v95, 0
    s_add_u32 s40, s39, 2097152
    s_mov_b32 s43, 0
k2_af2:
    buffer_load_dwordx4 v[12:15], v46, s[12:15], s40 offen sc1
    s_mov_b64 exec, s[36:37]
    buffer_load_dwordx4 v[20:23], v45, s[12:15], s41 offen sc1
    buffer_load_dwordx4 v[24:27], v45, s[12:15], s41 offen offset:512 sc1
    s_mov_b64 exec, -1
    s_add_u32 s40, s40, 1024
    s_add_u32 s41, s41, 1024
    s_waitcnt vmcnt(0)
    v_mfma_f32_32x32x16_bf16 v[48:63], v[12:15], v[4:7], v[64:79]
    s_nop 7
    s_nop 3
    v_exp_f32 v48, v48
    v_exp_f32 v49, v49
    v_exp_f32 v50, v50
    v_exp_f32 v51, v51
    v_exp_f32 v52, v52
    v_exp_f32 v53, v53
    v_exp_f32 v54, v54
    v_exp_f32 v55, v55
    v_cvt_pk_bf16_f32 v36, v48, v49
    v_cvt_pk_bf16_f32 v37, v50, v51
    v_cvt_pk_bf16_f32 v38, v52, v53
    v_cvt_pk_bf16_f32 v39, v54, v55
    v_exp_f32 v56, v56
    v_exp_f32 v57, v57
    v_mfma_f32_32x32x16_bf16 v[80:95], v[20:23], v[36:39], v[80:95]
    v_exp_f32 v58, v58
    v_exp_f32 v59, v59
    v_exp_f32 v60, v60
    v_exp_f32 v61, v61
    v_exp_f32 v62, v62
    v_exp_f32 v63, v63
    v_cvt_pk_bf16_f32 v40, v56, v57
    v_cvt_pk_bf16_f32 v41, v58, v59
    v_cvt_pk_bf16_f32 v42, v60, v61
    v_cvt_pk_bf16_f32 v43, v62, v63
    s_nop 1
    v_mfma_f32_32x32x16_bf16 v[80:95], v[24:27], v[40:43], v[80:95]
    s_add_u32 s43, s43, 1
    s_cmp_lt_u32 s43, 64
    s_nop 7
    s_nop 3
    s_cbranch_scc1 k2_af2
    s_branch k2_aepi
k2_dq5:
    s_waitcnt lgkmcnt(0)
    s_or_b32 s74, s68, s69
    s_or_b32 s74, s74, s70
    s_cmp_eq_u32 s74, 1
    s_cbranch_scc0 k2_dn5
    s_mov_b32 m0, s42
    s_nop 0
    buffer_load_dwordx4 v46, s[12:15], s40 offen sc1 lds
    buffer_load_dwordx4 v46, s[12:15], s40 offen offset:1024 sc1 lds
    s_add_u32 m0, s42, 16384
    s_add_u32 s47, s47, 16384
    buffer_load_dwordx4 v46, s[12:15], s41 offen sc1 lds
    buffer_load_dwordx4 v46, s[12:15], s41 offen offset:1024 sc1 lds
    s_and_b32 s47, s47, 0xffff
    s_add_u32 s40, s47, s62
    s_add_u32 s41, s40, 2097152
    s_xor_b32 s42, s42, 32768
    s_mov_b32 s49, 0
    s_branch k2_dr5
k2_dn5:
    s_load_dwordx4 s[68:71], s[64:65], 8 glc
    s_branch k2_dr5
k2_dq13:
    s_waitcnt lgkmcnt(0)
    s_or_b32 s74, s68, s69
    s_or_b32 s74, s74, s70
    s_cmp_eq_u32 s74, 1
    s_cbranch_scc0 k2_dn13
    s_mov_b32 m0, s42
    s_nop 0
    buffer_load_dwordx4 v46, s[12:15], s40 offen sc1 lds
    buffer_load_dwordx4 v46, s[12:15], s40 offen offset:1024 sc1 lds
    s_add_u32 m0, s42, 16384
    s_add_u32 s47, s47, 16384
    buffer_load_dwordx4 v46, s[12:15], s41 offen sc1 lds
    buffer_load_dwordx4 v46, s[12:15], s41 offen offset:1024 sc1 lds
    s_and_b32 s47, s47, 0xffff
    s_add_u32 s40, s47, s62
    s_add_u32 s41, s40, 2097152
    s_xor_b32 s42, s42, 32768
    s_mov_b32 s49, 0
    s_branch k2_dr13
k2_dn13:
    s_load_dwordx4 s[68:71], s[64:65], 8 glc
    s_add_u32 s53, s53, 1
    s_cmp_lt_u32 s53, 400
    s_cbranch_scc1 k2_dq13
    s_waitcnt lgkmcnt(0)
    s_mov_b32 s72, 0
    s_branch kf_apf
kf_gc:
    s_load_dwordx2 s[28:29], s[0:1], 48
    s_mov_b32 s30, 4096
    s_mov_b32 s31, 0x00020000
    s_lshr_b32 s44, s32, 1
    s_lshl_b32 s44, s44, 13
    s_and_b32 s45, s32, 1
    s_lshl_b32 s45, s45, 6
    s_add_u32 s44, s44, s45
    v_bfe_u32 v13, v1, 2, 2
    v_lshl_add_u32 v13, v3, 3, v13
    v_and_b32 v14, 1, v1
    v_bfe_u32 v15, v1, 1, 1
    v_lshl_add_u32 v14, v14, 1, v15
    v_lshlrev_b32 v14, 3, v14
    v_bfe_u32 v15, v1, 4, 1
    v_lshl_add_u32 v14, v15, 5, v14
    v_add_u32 v14, s44, v14
    v_bfe_u32 v15, v1, 3, 1
    v_lshlrev_b32 v15, 6, v15
    v_xor_b32 v14, v14, v15
    v_lshl_add_u32 v12, v13, 7, v14
    v_bfe_u32 v13, v1, 1, 3
    v_xor_b32 v13, v13, v3
    v_lshlrev_b32 v13, 4, v13
    v_lshl_add_u32 v5, v2, 7, v13
    v_add_u32 v5, 16384, v5
    v_xor_b32 v6, 32, v5
    v_xor_b32 v7, 64, v5
    v_xor_b32 v8, 96, v5
    v_bfe_u32 v13, v1, 2, 2
    v_lshlrev_b32 v13, 5, v13
    v_lshl_add_u32 v13, v3, 9, v13
    v_and_b32 v14, 1, v1
    v_bfe_u32 v15, v1, 1, 1
    v_lshl_add_u32 v14, v14, 1, v15
    v_lshl_add_u32 v13, v14, 3, v13
    v_bfe_u32 v15, v1, 4, 1
    v_lshl_add_u32 v13, v15, 7, v13
    s_lshl_b32 s45, s32, 12
    v_add_u32 v4, s45, v13
    v_lshrrev_b32 v13, 2, v2
    v_lshlrev_b32 v13, 8, v13
    v_and_b32 v14, 3, v2
    v_lshl_add_u32 v13, v14, 5, v13
    v_lshl_add_u32 v13, v3, 4, v13
    v_lshlrev_b32 v9, 4, v1
    s_lshl_b32 s46, s38, 1
    s_lshl_b32 s47, s57, 2
    s_add_u32 s47, s47, s32
    s_lshl_b32 s48, s47, 17
    s_lshl_b32 s49, s56, 12
    s_add_u32 s48, s48, s49
    s_add_u32 s48, s48, 14680064
    s_lshl_b32 s54, s57, 7
    s_lshl_b32 s49, s32, 2
    s_add_u32 s54, s54, s49
    s_mul_i32 s49, s56, 8320
    s_add_u32 s54, s54, s49
    s_add_u32 s54, s54, 19404800
    s_lshl_b32 s47, s35, 2
    s_add_u32 s47, s47, s32
    s_mul_i32 s58, s38, 28
    s_add_u32 s58, s58, s47
    s_lshl_b32 s58, s58, 12
    s_add_u32 s58, s58, 6291456
    s_lshl_b32 s49, s47, 11
    s_mul_i32 s50, s46, 90112
    s_add_u32 s50, s50, s49
    s_add_u32 s50, s50, 21004288
    s_add_u32 s55, s50, 90112
    s_lshl_b32 s52, s46, 6
    s_mov_b32 s72, 0xbdd2d3e8
    s_mov_b32 s73, 0xc0135761
    s_waitcnt lgkmcnt(0)
    s_barrier
    ds_read_b64_tr_b16 v[16:17], v12 offset:0
    ds_read_b64_tr_b16 v[18:19], v12 offset:512
    ds_read_b128 v[20:23], v5 offset:0
    ds_read_b128 v[24:27], v5 offset:4096
    ds_read_b64_tr_b16 v[28:29], v12 offset:2048
    ds_read_b64_tr_b16 v[30:31], v12 offset:2560
    ds_read_b128 v[32:35], v6 offset:0
    ds_read_b128 v[36:39], v6 offset:4096
    ds_read_b64_tr_b16 v[40:41], v12 offset:4096
    ds_read_b64_tr_b16 v[42:43], v12 offset:4608
    ds_read_b128 v[44:47], v7 offset:0
    ds_read_b128 v[48:51], v7 offset:4096
    ds_read_b64_tr_b16 v[52:53], v12 offset:6144
    ds_read_b64_tr_b16 v[54:55], v12 offset:6656
    ds_read_b128 v[56:59], v8 offset:0
    ds_read_b128 v[60:63], v8 offset:4096
    s_waitcnt lgkmcnt(8)
    v_mfma_f32_32x32x16_bf16 v[64:79], v[16:19], v[20:23], 0
    v_mfma_f32_32x32x16_bf16 v[80:95], v[16:19], v[24:27], 0
    v_mfma_f32_32x32x16_bf16 v[64:79], v[28:31], v[32:35], v[64:79]
    v_mfma_f32_32x32x16_bf16 v[80:95], v[28:31], v[36:39], v[80:95]
    s_waitcnt lgkmcnt(0)
    s_barrier
    ds_read_b64_tr_b16 v[16:17], v12 offset:24576
    ds_read_b64_tr_b16 v[18:19], v12 offset:25088
    ds_read_b128 v[20:23], v5 offset:24576
    ds_read_b128 v[24:27], v5 offset:28672
    ds_read_b64_tr_b16 v[28:29], v12 offset:26624
    ds_read_b64_tr_b16 v[30:31], v12 offset:27136
    ds_read_b128 v[32:35], v6 offset:24576
    ds_read_b128 v[36:39], v6 offset:28672
    v_mfma_f32_32x32x16_bf16 v[64:79], v[40:43], v[44:47], v[64:79]
    v_mfma_f32_32x32x16_bf16 v[80:95], v[40:43], v[48:51], v[80:95]
    v_mfma_f32_32x32x16_bf16 v[64:79], v[52:55], v[56:59], v[64:79]
    v_mfma_f32_32x32x16_bf16 v[80:95], v[52:55], v[60:63], v[80:95]
    ds_read_b64_tr_b16 v[40:41], v12 offset:28672
    ds_read_b64_tr_b16 v[42:43], v12 offset:29184
    ds_read_b128 v[44:47], v7 offset:24576
    ds_read_b128 v[48:51], v7 offset:28672
    ds_read_b64_tr_b16 v[52:53], v12 offset:30720
    ds_read_b64_tr_b16 v[54:55], v12 offset:31232
    ds_read_b128 v[56:59], v8 offset:24576
    ds_read_b128 v[60:63], v8 offset:28672
    s_waitcnt lgkmcnt(8)
    v_mfma_f32_32x32x16_bf16 v[64:79], v[16:19], v[20:23], v[64:79]
    v_mfma_f32_32x32x16_bf16 v[80:95], v[16:19], v[24:27], v[80:95]
    v_mfma_f32_32x32x16_bf16 v[64:79], v[28:31], v[32:35], v[64:79]
    v_mfma_f32_32x32x16_bf16 v[80:95], v[28:31], v[36:39], v[80:95]
    s_waitcnt lgkmcnt(0)
    s_barrier
    ds_read_b64_tr_b16 v[16:17], v12 offset:49152
    ds_read_b64_tr_b16 v[18:19], v12 offset:49664
    ds_read_b128 v[20:23], v5 offset:49152
    ds_read_b128 v[24:27], v5 offset:53248
    ds_read_b64_tr_b16 v[28:29], v12 offset:51200
    ds_read_b64_tr_b16 v[30:31], v12 offset:51712
    ds_read_b128 v[32:35], v6 offset:49152
    ds_read_b128 v[36:39], v6 offset:53248
    v_mfma_f32_32x32x16_bf16 v[64:79], v[40:43], v[44:47], v[64:79]
    v_mfma_f32_32x32x16_bf16 v[80:95], v[40:43], v[48:51], v[80:95]
    v_mfma_f32_32x32x16_bf16 v[64:79], v[52:55], v[56:59], v[64:79]
    v_mfma_f32_32x32x16_bf16 v[80:95], v[52:55], v[60:63], v[80:95]
    ds_read_b64_tr_b16 v[40:41], v12 offset:53248
    ds_read_b64_tr_b16 v[42:43], v12 offset:53760
    ds_read_b128 v[44:47], v7 offset:49152
    ds_read_b128 v[48:51], v7 offset:53248
    ds_read_b64_tr_b16 v[52:53], v12 offset:55296
    ds_read_b64_tr_b16 v[54:55], v12 offset:55808
    ds_read_b128 v[56:59], v8 offset:49152
    ds_read_b128 v[60:63], v8 offset:53248
    s_waitcnt lgkmcnt(8)
    v_mfma_f32_32x32x16_bf16 v[64:79], v[16:19], v[20:23], v[64:79]
    v_mfma_f32_32x32x16_bf16 v[80:95], v[16:19], v[24:27], v[80:95]
    v_mfma_f32_32x32x16_bf16 v[64:79], v[28:31], v[32:35], v[64:79]
    v_mfma_f32_32x32x16_bf16 v[80:95], v[28:31], v[36:39], v[80:95]
    s_waitcnt lgkmcnt(0)
    s_barrier
    ds_read_b64_tr_b16 v[16:17], v12 offset:0
    ds_read_b64_tr_b16 v[18:19], v12 offset:512
    ds_read_b128 v[20:23], v5 offset:0
    ds_read_b128 v[24:27], v5 offset:4096
    ds_read_b64_tr_b16 v[28:29], v12 offset:2048
    ds_read_b64_tr_b16 v[30:31], v12 offset:2560
    ds_read_b128 v[32:35], v6 offset:0
    ds_read_b128 v[36:39], v6 offset:4096
    v_mfma_f32_32x32x16_bf16 v[64:79], v[40:43], v[44:47], v[64:79]
    v_mfma_f32_32x32x16_bf16 v[80:95], v[40:43], v[48:51], v[80:95]
    v_mfma_f32_32x32x16_bf16 v[64:79], v[52:55], v[56:59], v[64:79]
    v_mfma_f32_32x32x16_bf16 v[80:95], v[52:55], v[60:63], v[80:95]
    ds_read_b64_tr_b16 v[40:41], v12 offset:4096
    ds_read_b64_tr_b16 v[42:43], v12 offset:4608
    ds_read_b128 v[44:47], v7 offset:0
    ds_read_b128 v[48:51], v7 offset:4096
    ds_read_b64_tr_b16 v[52:53], v12 offset:6144
    ds_read_b64_tr_b16 v[54:55], v12 offset:6656
    ds_read_b128 v[56:59], v8 offset:0
    ds_read_b128 v[60:63], v8 offset:4096
    s_waitcnt lgkmcnt(8)
    v_mfma_f32_32x32x16_bf16 v[64:79], v[16:19], v[20:23], v[64:79]
    v_mfma_f32_32x32x16_bf16 v[80:95], v[16:19], v[24:27], v[80:95]
    v_mfma_f32_32x32x16_bf16 v[64:79], v[28:31], v[32:35], v[64:79]
    v_mfma_f32_32x32x16_bf16 v[80:95], v[28:31], v[36:39], v[80:95]
    s_waitcnt lgkmcnt(0)
    s_barrier
    ds_read_b64_tr_b16 v[16:17], v12 offset:24576
    ds_read_b64_tr_b16 v[18:19], v12 offset:25088
    ds_read_b128 v[20:23], v5 offset:24576
    ds_read_b128 v[24:27], v5 offset:28672
    ds_read_b64_tr_b16 v[28:29], v12 offset:26624
    ds_read_b64_tr_b16 v[30:31], v12 offset:27136
    ds_read_b128 v[32:35], v6 offset:24576
    ds_read_b128 v[36:39], v6 offset:28672
    v_mfma_f32_32x32x16_bf16 v[64:79], v[40:43], v[44:47], v[64:79]
    v_mfma_f32_32x32x16_bf16 v[80:95], v[40:43], v[48:51], v[80:95]
    v_mfma_f32_32x32x16_bf16 v[64:79], v[52:55], v[56:59], v[64:79]
    v_mfma_f32_32x32x16_bf16 v[80:95], v[52:55], v[60:63], v[80:95]
    ds_read_b64_tr_b16 v[40:41], v12 offset:28672
    ds_read_b64_tr_b16 v[42:43], v12 offset:29184
    ds_read_b128 v[44:47], v7 offset:24576
    ds_read_b128 v[48:51], v7 offset:28672
    ds_read_b64_tr_b16 v[52:53], v12 offset:30720
    ds_read_b64_tr_b16 v[54:55], v12 offset:31232
    ds_read_b128 v[56:59], v8 offset:24576
    ds_read_b128 v[60:63], v8 offset:28672
    s_waitcnt lgkmcnt(8)
    v_mfma_f32_32x32x16_bf16 v[64:79], v[16:19], v[20:23], v[64:79]
    v_mfma_f32_32x32x16_bf16 v[80:95], v[16:19], v[24:27], v[80:95]
    v_mfma_f32_32x32x16_bf16 v[64:79], v[28:31], v[32:35], v[64:79]
    v_mfma_f32_32x32x16_bf16 v[80:95], v[28:31], v[36:39], v[80:95]
    s_waitcnt lgkmcnt(0)
    s_barrier
    ds_read_b64_tr_b16 v[16:17], v12 offset:49152
    ds_read_b64_tr_b16 v[18:19], v12 offset:49664
    ds_read_b128 v[20:23], v5 offset:49152
    ds_read_b128 v[24:27], v5 offset:53248
    ds_read_b64_tr_b16 v[28:29], v12 offset:51200
    ds_read_b64_tr_b16 v[30:31], v12 offset:51712
    ds_read_b128 v[32:35], v6 offset:49152
    ds_read_b128 v[36:39], v6 offset:53248
    v_mfma_f32_32x32x16_bf16 v[64:79], v[40:43], v[44:47], v[64:79]
    v_mfma_f32_32x32x16_bf16 v[80:95], v[40:43], v[48:51], v[80:95]
    v_mfma_f32_32x32x16_bf16 v[64:79], v[52:55], v[56:59], v[64:79]
    v_mfma_f32_32x32x16_bf16 v[80:95], v[52:55], v[60:63], v[80:95]
    ds_read_b64_tr_b16 v[40:41], v12 offset:53248
    ds_read_b64_tr_b16 v[42:43], v12 offset:53760
    ds_read_b128 v[44:47], v7 offset:49152
    ds_read_b128 v[48:51], v7 offset:53248
    ds_read_b64_tr_b16 v[52:53], v12 offset:55296
    ds_read_b64_tr_b16 v[54:55], v12 offset:55808
    ds_read_b128 v[56:59], v8 offset:49152
    ds_read_b128 v[60:63], v8 offset:53248
    s_waitcnt lgkmcnt(8)
    v_mfma_f32_32x32x16_bf16 v[64:79], v[16:19], v[20:23], v[64:79]
    v_mfma_f32_32x32x16_bf16 v[80:95], v[16:19], v[24:27], v[80:95]
    v_mfma_f32_32x32x16_bf16 v[64:79], v[28:31], v[32:35], v[64:79]
    v_mfma_f32_32x32x16_bf16 v[80:95], v[28:31], v[36:39], v[80:95]
    s_waitcnt lgkmcnt(0)
    s_barrier
    ds_read_b64_tr_b16 v[16:17], v12 offset:0
    ds_read_b64_tr_b16 v[18:19], v12 offset:512
    ds_read_b128 v[20:23], v5 offset:0
    ds_read_b128 v[24:27], v5 offset:4096
    ds_read_b64_tr_b16 v[28:29], v12 offset:2048
    ds_read_b64_tr_b16 v[30:31], v12 offset:2560
    ds_read_b128 v[32:35], v6 offset:0
    ds_read_b128 v[36:39], v6 offset:4096
    v_mfma_f32_32x32x16_bf16 v[64:79], v[40:43], v[44:47], v[64:79]
    v_mfma_f32_32x32x16_bf16 v[80:95], v[40:43], v[48:51], v[80:95]
    v_mfma_f32_32x32x16_bf16 v[64:79], v[52:55], v[56:59], v[64:79]
    v_mfma_f32_32x32x16_bf16 v[80:95], v[52:55], v[60:63], v[80:95]
    ds_read_b64_tr_b16 v[40:41], v12 offset:4096
    ds_read_b64_tr_b16 v[42:43], v12 offset:4608
    ds_read_b128 v[44:47], v7 offset:0
    ds_read_b128 v[48:51], v7 offset:4096
    ds_read_b64_tr_b16 v[52:53], v12 offset:6144
    ds_read_b64_tr_b16 v[54:55], v12 offset:6656
    ds_read_b128 v[56:59], v8 offset:0
    ds_read_b128 v[60:63], v8 offset:4096
    s_waitcnt lgkmcnt(8)
    v_mfma_f32_32x32x16_bf16 v[64:79], v[16:19], v[20:23], v[64:79]
    v_mfma_f32_32x32x16_bf16 v[80:95], v[16:19], v[24:27], v[80:95]
    v_mfma_f32_32x32x16_bf16 v[64:79], v[28:31], v[32:35], v[64:79]
    v_mfma_f32_32x32x16_bf16 v[80:95], v[28:31], v[36:39], v[80:95]
    s_waitcnt lgkmcnt(0)
    s_barrier
    ds_read_b64_tr_b16 v[16:17], v12 offset:24576
    ds_read_b64_tr_b16 v[18:19], v12 offset:25088
    ds_read_b128 v[20:23], v5 offset:24576
    ds_read_b128 v[24:27], v5 offset:28672
    ds_read_b64_tr_b16 v[28:29], v12 offset:26624
    ds_read_b64_tr_b16 v[30:31], v12 offset:27136
    ds_read_b128 v[32:35], v6 offset:24576
    ds_read_b128 v[36:39], v6 offset:28672
    v_mfma_f32_32x32x16_bf16 v[64:79], v[40:43], v[44:47], v[64:79]
    v_mfma_f32_32x32x16_bf16 v[80:95], v[40:43], v[48:51], v[80:95]
    v_mfma_f32_32x32x16_bf16 v[64:79], v[52:55], v[56:59], v[64:79]
    v_mfma_f32_32x32x16_bf16 v[80:95], v[52:55], v[60:63], v[80:95]
    ds_read_b64_tr_b16 v[40:41], v12 offset:28672
    ds_read_b64_tr_b16 v[42:43], v12 offset:29184
    ds_read_b128 v[44:47], v7 offset:24576
    ds_read_b128 v[48:51], v7 offset:28672
    ds_read_b64_tr_b16 v[52:53], v12 offset:30720
    ds_read_b64_tr_b16 v[54:55], v12 offset:31232
    ds_read_b128 v[56:59], v8 offset:24576
    ds_read_b128 v[60:63], v8 offset:28672
    s_waitcnt lgkmcnt(8)
    v_mfma_f32_32x32x16_bf16 v[64:79], v[16:19], v[20:23], v[64:79]
    v_mfma_f32_32x32x16_bf16 v[80:95], v[16:19], v[24:27], v[80:95]
    v_mfma_f32_32x32x16_bf16 v[64:79], v[28:31], v[32:35], v[64:79]
    v_mfma_f32_32x32x16_bf16 v[80:95], v[28:31], v[36:39], v[80:95]
    s_waitcnt lgkmcnt(0)
    v_mfma_f32_32x32x16_bf16 v[64:79], v[40:43], v[44:47], v[64:79]
    v_mfma_f32_32x32x16_bf16 v[80:95], v[40:43], v[48:51], v[80:95]
    v_mfma_f32_32x32x16_bf16 v[64:79], v[52:55], v[56:59], v[64:79]
    v_mfma_f32_32x32x16_bf16 v[80:95], v[52:55], v[60:63], v[80:95]
    s_lshl_b32 s44, s32, 9
    s_add_u32 s44, s44, 73728
    v_lshlrev_b32 v24, 2, v1
    v_add_u32 v24, s44, v24
    s_nop 7
    v_pk_mul_f32 v[32:33], v[64:65], v[64:65]
    v_pk_mul_f32 v[34:35], v[66:67], v[66:67]
    v_pk_mul_f32 v[36:37], v[68:69], v[68:69]
    v_pk_mul_f32 v[38:39], v[70:71], v[70:71]
    v_pk_fma_f32 v[32:33], v[32:33], s[72:73], s[72:73] op_sel:[0,0,1] op_sel_hi:[1,0,1]
    v_pk_fma_f32 v[34:35], v[34:35], s[72:73], s[72:73] op_sel:[0,0,1] op_sel_hi:[1,0,1]
    v_pk_fma_f32 v[36:37], v[36:37], s[72:73], s[72:73] op_sel:[0,0,1] op_sel_hi:[1,0,1]
    v_pk_fma_f32 v[38:39], v[38:39], s[72:73], s[72:73] op_sel:[0,0,1] op_sel_hi:[1,0,1]
    v_pk_mul_f32 v[32:33], v[32:33], v[64:65]
    v_pk_mul_f32 v[34:35], v[34:35], v[66:67]
    v_pk_mul_f32 v[36:37], v[36:37], v[68:69]
    v_pk_mul_f32 v[38:39], v[38:39], v[70:71]
    v_exp_f32 v32, v32
    v_exp_f32 v33, v33
    v_exp_f32 v34, v34
    v_exp_f32 v35, v35
    v_exp_f32 v36, v36
    v_exp_f32 v37, v37
    v_exp_f32 v38, v38
    v_exp_f32 v39, v39
    v_pk_add_f32 v[32:33], v[32:33], 1.0 op_sel_hi:[1,0]
    v_pk_add_f32 v[34:35], v[34:35], 1.0 op_sel_hi:[1,0]
    v_pk_add_f32 v[36:37], v[36:37], 1.0 op_sel_hi:[1,0]
    v_pk_add_f32 v[38:39], v[38:39], 1.0 op_sel_hi:[1,0]
    v_rcp_f32 v32, v32
    v_rcp_f32 v33, v33
    v_rcp_f32 v34, v34
    v_rcp_f32 v35, v35
    v_rcp_f32 v36, v36
    v_rcp_f32 v37, v37
    v_rcp_f32 v38, v38
    v_rcp_f32 v39, v39
    v_pk_mul_f32 v[96:97], v[32:33], v[64:65]
    v_pk_mul_f32 v[98:99], v[34:35], v[66:67]
    v_pk_mul_f32 v[100:101], v[36:37], v[68:69]
    v_pk_mul_f32 v[102:103], v[38:39], v[70:71]
    v_pk_add_f32 v[16:17], v[96:97], v[98:99]
    v_pk_mul_f32 v[18:19], v[96:97], v[96:97]
    v_pk_fma_f32 v[18:19], v[98:99], v[98:99], v[18:19]
    v_pk_add_f32 v[16:17], v[16:17], v[100:101]
    v_pk_fma_f32 v[18:19], v[100:101], v[100:101], v[18:19]
    v_pk_add_f32 v[16:17], v[16:17], v[102:103]
    v_pk_fma_f32 v[18:19], v[102:103], v[102:103], v[18:19]
    v_pk_mul_f32 v[32:33], v[72:73], v[72:73]
    v_pk_mul_f32 v[34:35], v[74:75], v[74:75]
    v_pk_mul_f32 v[36:37], v[76:77], v[76:77]
    v_pk_mul_f32 v[38:39], v[78:79], v[78:79]
    v_pk_fma_f32 v[32:33], v[32:33], s[72:73], s[72:73] op_sel:[0,0,1] op_sel_hi:[1,0,1]
    v_pk_fma_f32 v[34:35], v[34:35], s[72:73], s[72:73] op_sel:[0,0,1] op_sel_hi:[1,0,1]
    v_pk_fma_f32 v[36:37], v[36:37], s[72:73], s[72:73] op_sel:[0,0,1] op_sel_hi:[1,0,1]
    v_pk_fma_f32 v[38:39], v[38:39], s[72:73], s[72:73] op_sel:[0,0,1] op_sel_hi:[1,0,1]
    v_pk_mul_f32 v[32:33], v[32:33], v[72:73]
    v_pk_mul_f32 v[34:35], v[34:35], v[74:75]
    v_pk_mul_f32 v[36:37], v[36:37], v[76:77]
    v_pk_mul_f32 v[38:39], v[38:39], v[78:79]
    v_exp_f32 v32, v32
    v_exp_f32 v33, v33
    v_exp_f32 v34, v34
    v_exp_f32 v35, v35
    v_exp_f32 v36, v36
    v_exp_f32 v37, v37
    v_exp_f32 v38, v38
    v_exp_f32 v39, v39
    v_pk_add_f32 v[32:33], v[32:33], 1.0 op_sel_hi:[1,0]
    v_pk_add_f32 v[34:35], v[34:35], 1.0 op_sel_hi:[1,0]
    v_pk_add_f32 v[36:37], v[36:37], 1.0 op_sel_hi:[1,0]
    v_pk_add_f32 v[38:39], v[38:39], 1.0 op_sel_hi:[1,0]
    v_rcp_f32 v32, v32
    v_rcp_f32 v33, v33
    v_rcp_f32 v34, v34
    v_rcp_f32 v35, v35
    v_rcp_f32 v36, v36
    v_rcp_f32 v37, v37
    v_rcp_f32 v38, v38
    v_rcp_f32 v39, v39
    v_pk_mul_f32 v[104:105], v[32:33], v[72:73]
    v_pk_mul_f32 v[106:107], v[34:35], v[74:75]
    v_pk_mul_f32 v[108:109], v[36:37], v[76:77]
    v_pk_mul_f32 v[110:111], v[38:39], v[78:79]
    v_pk_add_f32 v[16:17], v[16:17], v[104:105]
    v_pk_fma_f32 v[18:19], v[104:105], v[104:105], v[18:19]
    v_pk_add_f32 v[16:17], v[16:17], v[106:107]
    v_pk_fma_f32 v[18:19], v[106:107], v[106:107], v[18:19]
    v_pk_add_f32 v[16:17], v[16:17], v[108:109]
    v_pk_fma_f32 v[18:19], v[108:109], v[108:109], v[18:19]
    v_pk_add_f32 v[16:17], v[16:17], v[110:111]
    v_pk_fma_f32 v[18:19], v[110:111], v[110:111], v[18:19]
    v_pk_mul_f32 v[32:33], v[80:81], v[80:81]
    v_pk_mul_f32 v[34:35], v[82:83], v[82:83]
    v_pk_mul_f32 v[36:37], v[84:85], v[84:85]
    v_pk_mul_f32 v[38:39], v[86:87], v[86:87]
    v_pk_fma_f32 v[32:33], v[32:33], s[72:73], s[72:73] op_sel:[0,0,1] op_sel_hi:[1,0,1]
    v_pk_fma_f32 v[34:35], v[34:35], s[72:73], s[72:73] op_sel:[0,0,1] op_sel_hi:[1,0,1]
    v_pk_fma_f32 v[36:37], v[36:37], s[72:73], s[72:73] op_sel:[0,0,1] op_sel_hi:[1,0,1]
    v_pk_fma_f32 v[38:39], v[38:39], s[72:73], s[72:73] op_sel:[0,0,1] op_sel_hi:[1,0,1]
    v_pk_mul_f32 v[32:33], v[32:33], v[80:81]
    v_pk_mul_f32 v[34:35], v[34:35], v[82:83]
    v_pk_mul_f32 v[36:37], v[36:37], v[84:85]
    v_pk_mul_f32 v[38:39], v[38:39], v[86:87]
    v_exp_f32 v32, v32
    v_exp_f32 v33, v33
    v_exp_f32 v34, v34
    v_exp_f32 v35, v35
    v_exp_f32 v36, v36
    v_exp_f32 v37, v37
    v_exp_f32 v38, v38
    v_exp_f32 v39, v39
    v_pk_add_f32 v[32:33], v[32:33], 1.0 op_sel_hi:[1,0]
    v_pk_add_f32 v[34:35], v[34:35], 1.0 op_sel_hi:[1,0]
    v_pk_add_f32 v[36:37], v[36:37], 1.0 op_sel_hi:[1,0]
    v_pk_add_f32 v[38:39], v[38:39], 1.0 op_sel_hi:[1,0]
    v_rcp_f32 v32, v32
    v_rcp_f32 v33, v33
    v_rcp_f32 v34, v34
    v_rcp_f32 v35, v35
    v_rcp_f32 v36, v36
    v_rcp_f32 v37, v37
    v_rcp_f32 v38, v38
    v_rcp_f32 v39, v39
    v_pk_mul_f32 v[112:113], v[32:33], v[80:81]
    v_pk_mul_f32 v[114:115], v[34:35], v[82:83]
    v_pk_mul_f32 v[116:117], v[36:37], v[84:85]
    v_pk_mul_f32 v[118:119], v[38:39], v[86:87]
    v_pk_add_f32 v[20:21], v[112:113], v[114:115]
    v_pk_mul_f32 v[22:23], v[112:113], v[112:113]
    v_pk_fma_f32 v[22:23], v[114:115], v[114:115], v[22:23]
    v_pk_add_f32 v[20:21], v[20:21], v[116:117]
    v_pk_fma_f32 v[22:23], v[116:117], v[116:117], v[22:23]
    v_pk_add_f32 v[20:21], v[20:21], v[118:119]
    v_pk_fma_f32 v[22:23], v[118:119], v[118:119], v[22:23]
    v_pk_mul_f32 v[32:33], v[88:89], v[88:89]
    v_pk_mul_f32 v[34:35], v[90:91], v[90:91]
    v_pk_mul_f32 v[36:37], v[92:93], v[92:93]
    v_pk_mul_f32 v[38:39], v[94:95], v[94:95]
    v_pk_fma_f32 v[32:33], v[32:33], s[72:73], s[72:73] op_sel:[0,0,1] op_sel_hi:[1,0,1]
    v_pk_fma_f32 v[34:35], v[34:35], s[72:73], s[72:73] op_sel:[0,0,1] op_sel_hi:[1,0,1]
    v_pk_fma_f32 v[36:37], v[36:37], s[72:73], s[72:73] op_sel:[0,0,1] op_sel_hi:[1,0,1]
    v_pk_fma_f32 v[38:39], v[38:39], s[72:73], s[72:73] op_sel:[0,0,1] op_sel_hi:[1,0,1]
    v_pk_mul_f32 v[32:33], v[32:33], v[88:89]
    v_pk_mul_f32 v[34:35], v[34:35], v[90:91]
    v_pk_mul_f32 v[36:37], v[36:37], v[92:93]
    v_pk_mul_f32 v[38:39], v[38:39], v[94:95]
    v_exp_f32 v32, v32
    v_exp_f32 v33, v33
    v_exp_f32 v34, v34
    v_exp_f32 v35, v35
    v_exp_f32 v36, v36
    v_exp_f32 v37, v37
    v_exp_f32 v38, v38
    v_exp_f32 v39, v39
    v_pk_add_f32 v[32:33], v[32:33], 1.0 op_sel_hi:[1,0]
    v_pk_add_f32 v[34:35], v[34:35], 1.0 op_sel_hi:[1,0]
    v_pk_add_f32 v[36:37], v[36:37], 1.0 op_sel_hi:[1,0]
    v_pk_add_f32 v[38:39], v[38:39], 1.0 op_sel_hi:[1,0]
    v_rcp_f32 v32, v32
    v_rcp_f32 v33, v33
    v_rcp_f32 v34, v34
    v_rcp_f32 v35, v35
    v_rcp_f32 v36, v36
    v_rcp_f32 v37, v37
    v_rcp_f32 v38, v38
    v_rcp_f32 v39, v39
    v_pk_mul_f32 v[120:121], v[32:33], v[88:89]
    v_pk_mul_f32 v[122:123], v[34:35], v[90:91]
    v_pk_mul_f32 v[124:125], v[36:37], v[92:93]
    v_pk_mul_f32 v[126:127], v[38:39], v[94:95]
    v_pk_add_f32 v[20:21], v[20:21], v[120:121]
    v_pk_fma_f32 v[22:23], v[120:121], v[120:121], v[22:23]
    v_pk_add_f32 v[20:21], v[20:21], v[122:123]
    v_pk_fma_f32 v[22:23], v[122:123], v[122:123], v[22:23]
    v_pk_add_f32 v[20:21], v[20:21], v[124:125]
    v_pk_fma_f32 v[22:23], v[124:125], v[124:125], v[22:23]
    v_pk_add_f32 v[20:21], v[20:21], v[126:127]
    v_pk_fma_f32 v[22:23], v[126:127], v[126:127], v[22:23]
    v_add_f32 v16, v16, v17
    v_add_f32 v18, v18, v19
    v_add_f32 v20, v20, v21
    v_add_f32 v22, v22, v23
    s_nop 1
    v_permlane32_swap_b32 v16, v18
    v_permlane32_swap_b32 v20, v22
    s_nop 1
    v_add_f32 v16, v16, v18
    v_add_f32 v20, v20, v22
    ds_write2st64_b32 v24, v16, v20 offset0:0 offset1:1
    s_waitcnt lgkmcnt(0)
    s_barrier
    ds_read_b64_tr_b16 v[16:17], v12 offset:49152
    ds_read_b64_tr_b16 v[18:19], v12 offset:49664
    ds_read_b128 v[20:23], v5 offset:49152
    ds_read_b128 v[24:27], v5 offset:53248
    ds_read_b64_tr_b16 v[28:29], v12 offset:51200
    ds_read_b64_tr_b16 v[30:31], v12 offset:51712
    ds_read_b128 v[32:35], v6 offset:49152
    ds_read_b128 v[36:39], v6 offset:53248
    ds_read_b64_tr_b16 v[40:41], v12 offset:53248
    ds_read_b64_tr_b16 v[42:43], v12 offset:53760
    ds_read_b128 v[44:47], v7 offset:49152
    ds_read_b128 v[48:51], v7 offset:53248
    ds_read_b64_tr_b16 v[52:53], v12 offset:55296
    ds_read_b64_tr_b16 v[54:55], v12 offset:55808
    ds_read_b128 v[56:59], v8 offset:49152
    ds_read_b128 v[60:63], v8 offset:53248
    s_waitcnt lgkmcnt(8)
    v_mfma_f32_32x32x16_bf16 v[64:79], v[16:19], v[20:23], 0
    v_mfma_f32_32x32x16_bf16 v[80:95], v[16:19], v[24:27], 0
    v_mfma_f32_32x32x16_bf16 v[64:79], v[28:31], v[32:35], v[64:79]
    v_mfma_f32_32x32x16_bf16 v[80:95], v[28:31], v[36:39], v[80:95]
    s_waitcnt lgkmcnt(0)
    s_barrier
    ds_read_b64_tr_b16 v[16:17], v12 offset:0
    ds_read_b64_tr_b16 v[18:19], v12 offset:512
    ds_read_b128 v[20:23], v5 offset:0
    ds_read_b128 v[24:27], v5 offset:4096
    ds_read_b64_tr_b16 v[28:29], v12 offset:2048
    ds_read_b64_tr_b16 v[30:31], v12 offset:2560
    ds_read_b128 v[32:35], v6 offset:0
    ds_read_b128 v[36:39], v6 offset:4096
    v_mfma_f32_32x32x16_bf16 v[64:79], v[40:43], v[44:47], v[64:79]
    v_mfma_f32_32x32x16_bf16 v[80:95], v[40:43], v[48:51], v[80:95]
    v_mfma_f32_32x32x16_bf16 v[64:79], v[52:55], v[56:59], v[64:79]
    v_mfma_f32_32x32x16_bf16 v[80:95], v[52:55], v[60:63], v[80:95]
    ds_read_b64_tr_b16 v[40:41], v12 offset:4096
    ds_read_b64_tr_b16 v[42:43], v12 offset:4608
    ds_read_b128 v[44:47], v7 offset:0
    ds_read_b128 v[48:51], v7 offset:4096
    ds_read_b64_tr_b16 v[52:53], v12 offset:6144
    ds_read_b64_tr_b16 v[54:55], v12 offset:6656
    ds_read_b128 v[56:59], v8 offset:0
    ds_read_b128 v[60:63], v8 offset:4096
    s_waitcnt lgkmcnt(8)
    v_mfma_f32_32x32x16_bf16 v[64:79], v[16:19], v[20:23], v[64:79]
    v_mfma_f32_32x32x16_bf16 v[80:95], v[16:19], v[24:27], v[80:95]
    v_mfma_f32_32x32x16_bf16 v[64:79], v[28:31], v[32:35], v[64:79]
    v_mfma_f32_32x32x16_bf16 v[80:95], v[28:31], v[36:39], v[80:95]
    s_waitcnt lgkmcnt(0)
    s_barrier
    ds_read_b64_tr_b16 v[16:17], v12 offset:24576
    ds_read_b64_tr_b16 v[18:19], v12 offset:25088
    ds_read_b128 v[20:23], v5 offset:24576
    ds_read_b128 v[24:27], v5 offset:28672
    ds_read_b64_tr_b16 v[28:29], v12 offset:26624
    ds_read_b64_tr_b16 v[30:31], v12 offset:27136
    ds_read_b128 v[32:35], v6 offset:24576
    ds_read_b128 v[36:39], v6 offset:28672
    v_mfma_f32_32x32x16_bf16 v[64:79], v[40:43], v[44:47], v[64:79]
    v_mfma_f32_32x32x16_bf16 v[80:95], v[40:43], v[48:51], v[80:95]
    v_mfma_f32_32x32x16_bf16 v[64:79], v[52:55], v[56:59], v[64:79]
    v_mfma_f32_32x32x16_bf16 v[80:95], v[52:55], v[60:63], v[80:95]
    ds_read_b64_tr_b16 v[40:41], v12 offset:28672
    ds_read_b64_tr_b16 v[42:43], v12 offset:29184
    ds_read_b128 v[44:47], v7 offset:24576
    ds_read_b128 v[48:51], v7 offset:28672
    ds_read_b64_tr_b16 v[52:53], v12 offset:30720
    ds_read_b64_tr_b16 v[54:55], v12 offset:31232
    ds_read_b128 v[56:59], v8 offset:24576
    ds_read_b128 v[60:63], v8 offset:28672
    s_waitcnt lgkmcnt(8)
    v_mfma_f32_32x32x16_bf16 v[64:79], v[16:19], v[20:23], v[64:79]
    v_mfma_f32_32x32x16_bf16 v[80:95], v[16:19], v[24:27], v[80:95]
    v_mfma_f32_32x32x16_bf16 v[64:79], v[28:31], v[32:35], v[64:79]
    v_mfma_f32_32x32x16_bf16 v[80:95], v[28:31], v[36:39], v[80:95]
    s_waitcnt lgkmcnt(0)
    s_barrier
    ds_read_b64_tr_b16 v[16:17], v12 offset:49152
    ds_read_b64_tr_b16 v[18:19], v12 offset:49664
    ds_read_b128 v[20:23], v5 offset:49152
    ds_read_b128 v[24:27], v5 offset:53248
    ds_read_b64_tr_b16 v[28:29], v12 offset:51200
    ds_read_b64_tr_b16 v[30:31], v12 offset:51712
    ds_read_b128 v[32:35], v6 offset:49152
    ds_read_b128 v[36:39], v6 offset:53248
    v_mfma_f32_32x32x16_bf16 v[64:79], v[40:43], v[44:47], v[64:79]
    v_mfma_f32_32x32x16_bf16 v[80:95], v[40:43], v[48:51], v[80:95]
    v_mfma_f32_32x32x16_bf16 v[64:79], v[52:55], v[56:59], v[64:79]
    v_mfma_f32_32x32x16_bf16 v[80:95], v[52:55], v[60:63], v[80:95]
    ds_read_b64_tr_b16 v[40:41], v12 offset:53248
    ds_read_b64_tr_b16 v[42:43], v12 offset:53760
    ds_read_b128 v[44:47], v7 offset:49152
    ds_read_b128 v[48:51], v7 offset:53248
    ds_read_b64_tr_b16 v[52:53], v12 offset:55296
    ds_read_b64_tr_b16 v[54:55], v12 offset:55808
    ds_read_b128 v[56:59], v8 offset:49152
    ds_read_b128 v[60:63], v8 offset:53248
    s_waitcnt lgkmcnt(8)
    v_mfma_f32_32x32x16_bf16 v[64:79], v[16:19], v[20:23], v[64:79]
    v_mfma_f32_32x32x16_bf16 v[80:95], v[16:19], v[24:27], v[80:95]
    v_mfma_f32_32x32x16_bf16 v[64:79], v[28:31], v[32:35], v[64:79]
    v_mfma_f32_32x32x16_bf16 v[80:95], v[28:31], v[36:39], v[80:95]
    s_waitcnt lgkmcnt(0)
    s_barrier
    v_lshlrev_b32 v14, 4, v2
    v_add_u32 v14, 75776, v14
    ds_read_b64 v[10:11], v14
    ds_read_b64 v[14:15], v14 offset:8
    ds_read_b64_tr_b16 v[16:17], v12 offset:0
    ds_read_b64_tr_b16 v[18:19], v12 offset:512
    ds_read_b128 v[20:23], v5 offset:0
    ds_read_b128 v[24:27], v5 offset:4096
    ds_read_b64_tr_b16 v[28:29], v12 offset:2048
    ds_read_b64_tr_b16 v[30:31], v12 offset:2560
    ds_read_b128 v[32:35], v6 offset:0
    ds_read_b128 v[36:39], v6 offset:4096
    v_mfma_f32_32x32x16_bf16 v[64:79], v[40:43], v[44:47], v[64:79]
    v_mfma_f32_32x32x16_bf16 v[80:95], v[40:43], v[48:51], v[80:95]
    v_mfma_f32_32x32x16_bf16 v[64:79], v[52:55], v[56:59], v[64:79]
    v_mfma_f32_32x32x16_bf16 v[80:95], v[52:55], v[60:63], v[80:95]
    ds_read_b64_tr_b16 v[40:41], v12 offset:4096
    ds_read_b64_tr_b16 v[42:43], v12 offset:4608
    ds_read_b128 v[44:47], v7 offset:0
    ds_read_b128 v[48:51], v7 offset:4096
    ds_read_b64_tr_b16 v[52:53], v12 offset:6144
    ds_read_b64_tr_b16 v[54:55], v12 offset:6656
    ds_read_b128 v[56:59], v8 offset:0
    ds_read_b128 v[60:63], v8 offset:4096
    s_waitcnt lgkmcnt(15)
    v_pk_fma_f32 v[96:97], v[96:97], v[10:11], v[10:11] op_sel:[0,0,1] op_sel_hi:[1,0,1]
    v_pk_fma_f32 v[98:99], v[98:99], v[10:11], v[10:11] op_sel:[0,0,1] op_sel_hi:[1,0,1]
    v_pk_fma_f32 v[100:101], v[100:101], v[10:11], v[10:11] op_sel:[0,0,1] op_sel_hi:[1,0,1]
    v_pk_fma_f32 v[102:103], v[102:103], v[10:11], v[10:11] op_sel:[0,0,1] op_sel_hi:[1,0,1]
    v_cvt_pk_bf16_f32 v96, v96, v97
    v_cvt_pk_bf16_f32 v97, v98, v99
    v_cvt_pk_bf16_f32 v98, v100, v101
    v_cvt_pk_bf16_f32 v99, v102, v103
    buffer_store_dwordx4 v[96:99], v13, s[12:15], s48 offen offset:0 sc1
    v_pk_fma_f32 v[104:105], v[104:105], v[10:11], v[10:11] op_sel:[0,0,1] op_sel_hi:[1,0,1]
    v_pk_fma_f32 v[106:107], v[106:107], v[10:11], v[10:11] op_sel:[0,0,1] op_sel_hi:[1,0,1]
    v_pk_fma_f32 v[108:109], v[108:109], v[10:11], v[10:11] op_sel:[0,0,1] op_sel_hi:[1,0,1]
    v_pk_fma_f32 v[110:111], v[110:111], v[10:11], v[10:11] op_sel:[0,0,1] op_sel_hi:[1,0,1]
    v_cvt_pk_bf16_f32 v104, v104, v105
    v_cvt_pk_bf16_f32 v105, v106, v107
    v_cvt_pk_bf16_f32 v106, v108, v109
    v_cvt_pk_bf16_f32 v107, v110, v111
    buffer_store_dwordx4 v[104:107], v13, s[12:15], s48 offen offset:128 sc1
    v_pk_fma_f32 v[112:113], v[112:113], v[14:15], v[14:15] op_sel:[0,0,1] op_sel_hi:[1,0,1]
    v_pk_fma_f32 v[114:115], v[114:115], v[14:15], v[14:15] op_sel:[0,0,1] op_sel_hi:[1,0,1]
    v_pk_fma_f32 v[116:117], v[116:117], v[14:15], v[14:15] op_sel:[0,0,1] op_sel_hi:[1,0,1]
    v_pk_fma_f32 v[118:119], v[118:119], v[14:15], v[14:15] op_sel:[0,0,1] op_sel_hi:[1,0,1]
    v_cvt_pk_bf16_f32 v112, v112, v113
    v_cvt_pk_bf16_f32 v113, v114, v115
    v_cvt_pk_bf16_f32 v114, v116, v117
    v_cvt_pk_bf16_f32 v115, v118, v119
    buffer_store_dwordx4 v[112:115], v13, s[12:15], s48 offen offset:2048 sc1
    v_pk_fma_f32 v[120:121], v[120:121], v[14:15], v[14:15] op_sel:[0,0,1] op_sel_hi:[1,0,1]
    v_pk_fma_f32 v[122:123], v[122:123], v[14:15], v[14:15] op_sel:[0,0,1] op_sel_hi:[1,0,1]
    v_pk_fma_f32 v[124:125], v[124:125], v[14:15], v[14:15] op_sel:[0,0,1] op_sel_hi:[1,0,1]
    v_pk_fma_f32 v[126:127], v[126:127], v[14:15], v[14:15] op_sel:[0,0,1] op_sel_hi:[1,0,1]
    v_cvt_pk_bf16_f32 v120, v120, v121
    v_cvt_pk_bf16_f32 v121, v122, v123
    v_cvt_pk_bf16_f32 v122, v124, v125
    v_cvt_pk_bf16_f32 v123, v126, v127
    buffer_store_dwordx4 v[120:123], v13, s[12:15], s48 offen offset:2176 sc1
    s_waitcnt lgkmcnt(8)
    v_mfma_f32_32x32x16_bf16 v[64:79], v[16:19], v[20:23], v[64:79]
    v_mfma_f32_32x32x16_bf16 v[80:95], v[16:19], v[24:27], v[80:95]
    v_mfma_f32_32x32x16_bf16 v[64:79], v[28:31], v[32:35], v[64:79]
    v_mfma_f32_32x32x16_bf16 v[80:95], v[28:31], v[36:39], v[80:95]
    s_waitcnt lgkmcnt(0)
    s_barrier
    ds_read_b64_tr_b16 v[16:17], v12 offset:24576
    ds_read_b64_tr_b16 v[18:19], v12 offset:25088
    ds_read_b128 v[20:23], v5 offset:24576
    ds_read_b128 v[24:27], v5 offset:28672
    ds_read_b64_tr_b16 v[28:29], v12 offset:26624
    ds_read_b64_tr_b16 v[30:31], v12 offset:27136
    ds_read_b128 v[32:35], v6 offset:24576
    ds_read_b128 v[36:39], v6 offset:28672
    v_mfma_f32_32x32x16_bf16 v[64:79], v[40:43], v[44:47], v[64:79]
    v_mfma_f32_32x32x16_bf16 v[80:95], v[40:43], v[48:51], v[80:95]
    v_mfma_f32_32x32x16_bf16 v[64:79], v[52:55], v[56:59], v[64:79]
    v_mfma_f32_32x32x16_bf16 v[80:95], v[52:55], v[60:63], v[80:95]
    ds_read_b64_tr_b16 v[40:41], v12 offset:28672
    ds_read_b64_tr_b16 v[42:43], v12 offset:29184
    ds_read_b128 v[44:47], v7 offset:24576
    ds_read_b128 v[48:51], v7 offset:28672
    ds_read_b64_tr_b16 v[52:53], v12 offset:30720
    ds_read_b64_tr_b16 v[54:55], v12 offset:31232
    ds_read_b128 v[56:59], v8 offset:24576
    ds_read_b128 v[60:63], v8 offset:28672
    s_waitcnt lgkmcnt(8)
    v_mfma_f32_32x32x16_bf16 v[64:79], v[16:19], v[20:23], v[64:79]
    v_mfma_f32_32x32x16_bf16 v[80:95], v[16:19], v[24:27], v[80:95]
    v_mfma_f32_32x32x16_bf16 v[64:79], v[28:31], v[32:35], v[64:79]
    v_mfma_f32_32x32x16_bf16 v[80:95], v[28:31], v[36:39], v[80:95]
    s_waitcnt vmcnt(0)
    s_waitcnt lgkmcnt(0)
    s_barrier
    ds_read_b64_tr_b16 v[16:17], v12 offset:49152
    ds_read_b64_tr_b16 v[18:19], v12 offset:49664
    ds_read_b128 v[20:23], v5 offset:49152
    ds_read_b128 v[24:27], v5 offset:53248
    ds_read_b64_tr_b16 v[28:29], v12 offset:51200
    ds_read_b64_tr_b16 v[30:31], v12 offset:51712
    ds_read_b128 v[32:35], v6 offset:49152
    ds_read_b128 v[36:39], v6 offset:53248
    v_mfma_f32_32x32x16_bf16 v[64:79], v[40:43], v[44:47], v[64:79]
    v_mfma_f32_32x32x16_bf16 v[80:95], v[40:43], v[48:51], v[80:95]
    v_mfma_f32_32x32x16_bf16 v[64:79], v[52:55], v[56:59], v[64:79]
    v_mfma_f32_32x32x16_bf16 v[80:95], v[52:55], v[60:63], v[80:95]
    ds_read_b64_tr_b16 v[40:41], v12 offset:53248
    ds_read_b64_tr_b16 v[42:43], v12 offset:53760
    ds_read_b128 v[44:47], v7 offset:49152
    ds_read_b128 v[48:51], v7 offset:53248
    ds_read_b64_tr_b16 v[52:53], v12 offset:55296
    ds_read_b64_tr_b16 v[54:55], v12 offset:55808
    ds_read_b128 v[56:59], v8 offset:49152
    ds_read_b128 v[60:63], v8 offset:53248
    s_waitcnt lgkmcnt(8)
    v_mfma_f32_32x32x16_bf16 v[64:79], v[16:19], v[20:23], v[64:79]
    v_mfma_f32_32x32x16_bf16 v[80:95], v[16:19], v[24:27], v[80:95]
    v_mfma_f32_32x32x16_bf16 v[64:79], v[28:31], v[32:35], v[64:79]
    v_mfma_f32_32x32x16_bf16 v[80:95], v[28:31], v[36:39], v[80:95]
    s_waitcnt lgkmcnt(0)
    s_barrier
    ds_read_b64_tr_b16 v[16:17], v12 offset:0
    ds_read_b64_tr_b16 v[18:19], v12 offset:512
    ds_read_b128 v[20:23], v5 offset:0
    ds_read_b128 v[24:27], v5 offset:4096
    ds_read_b64_tr_b16 v[28:29], v12 offset:2048
    ds_read_b64_tr_b16 v[30:31], v12 offset:2560
    ds_read_b128 v[32:35], v6 offset:0
    ds_read_b128 v[36:39], v6 offset:4096
    v_mfma_f32_32x32x16_bf16 v[64:79], v[40:43], v[44:47], v[64:79]
    v_mfma_f32_32x32x16_bf16 v[80:95], v[40:43], v[48:51], v[80:95]
    v_mfma_f32_32x32x16_bf16 v[64:79], v[52:55], v[56:59], v[64:79]
    v_mfma_f32_32x32x16_bf16 v[80:95], v[52:55], v[60:63], v[80:95]
    ds_read_b64_tr_b16 v[40:41], v12 offset:4096
    ds_read_b64_tr_b16 v[42:43], v12 offset:4608
    ds_read_b128 v[44:47], v7 offset:0
    ds_read_b128 v[48:51], v7 offset:4096
    ds_read_b64_tr_b16 v[52:53], v12 offset:6144
    ds_read_b64_tr_b16 v[54:55], v12 offset:6656
    ds_read_b128 v[56:59], v8 offset:0
    ds_read_b128 v[60:63], v8 offset:4096
    s_waitcnt lgkmcnt(8)
    v_mfma_f32_32x32x16_bf16 v[64:79], v[16:19], v[20:23], v[64:79]
    v_mfma_f32_32x32x16_bf16 v[80:95], v[16:19], v[24:27], v[80:95]
    v_mfma_f32_32x32x16_bf16 v[64:79], v[28:31], v[32:35], v[64:79]
    v_mfma_f32_32x32x16_bf16 v[80:95], v[28:31], v[36:39], v[80:95]
    s_waitcnt lgkmcnt(0)
    v_mfma_f32_32x32x16_bf16 v[64:79], v[40:43], v[44:47], v[64:79]
    v_mfma_f32_32x32x16_bf16 v[80:95], v[40:43], v[48:51], v[80:95]
    v_mfma_f32_32x32x16_bf16 v[64:79], v[52:55], v[56:59], v[64:79]
    v_mfma_f32_32x32x16_bf16 v[80:95], v[52:55], v[60:63], v[80:95]
    s_nop 7
    s_nop 3
    v_pk_mul_f32 v[32:33], v[64:65], v[64:65]
    v_pk_mul_f32 v[34:35], v[66:67], v[66:67]
    v_pk_mul_f32 v[36:37], v[68:69], v[68:69]
    v_pk_mul_f32 v[38:39], v[70:71], v[70:71]
    v_pk_fma_f32 v[32:33], v[32:33], s[72:73], s[72:73] op_sel:[0,0,1] op_sel_hi:[1,0,1]
    v_pk_fma_f32 v[34:35], v[34:35], s[72:73], s[72:73] op_sel:[0,0,1] op_sel_hi:[1,0,1]
    v_pk_fma_f32 v[36:37], v[36:37], s[72:73], s[72:73] op_sel:[0,0,1] op_sel_hi:[1,0,1]
    v_pk_fma_f32 v[38:39], v[38:39], s[72:73], s[72:73] op_sel:[0,0,1] op_sel_hi:[1,0,1]
    v_pk_mul_f32 v[32:33], v[32:33], v[64:65]
    v_pk_mul_f32 v[34:35], v[34:35], v[66:67]
    v_pk_mul_f32 v[36:37], v[36:37], v[68:69]
    v_pk_mul_f32 v[38:39], v[38:39], v[70:71]
    v_exp_f32 v32, v32
    v_exp_f32 v33, v33
    v_exp_f32 v34, v34
    v_exp_f32 v35, v35
    v_exp_f32 v36, v36
    v_exp_f32 v37, v37
    v_exp_f32 v38, v38
    v_exp_f32 v39, v39
    v_pk_add_f32 v[32:33], v[32:33], 1.0 op_sel_hi:[1,0]
    v_pk_add_f32 v[34:35], v[34:35], 1.0 op_sel_hi:[1,0]
    v_pk_add_f32 v[36:37], v[36:37], 1.0 op_sel_hi:[1,0]
    v_pk_add_f32 v[38:39], v[38:39], 1.0 op_sel_hi:[1,0]
    v_rcp_f32 v32, v32
    v_rcp_f32 v33, v33
    v_rcp_f32 v34, v34
    v_rcp_f32 v35, v35
    v_rcp_f32 v36, v36
    v_rcp_f32 v37, v37
    v_rcp_f32 v38, v38
    v_rcp_f32 v39, v39
    v_pk_mul_f32 v[96:97], v[32:33], v[64:65]
    v_pk_mul_f32 v[98:99], v[34:35], v[66:67]
    v_pk_mul_f32 v[100:101], v[36:37], v[68:69]
    v_pk_mul_f32 v[102:103], v[38:39], v[70:71]
    v_pk_mul_f32 v[32:33], v[72:73], v[72:73]
    v_pk_mul_f32 v[34:35], v[74:75], v[74:75]
    v_pk_mul_f32 v[36:37], v[76:77], v[76:77]
    v_pk_mul_f32 v[38:39], v[78:79], v[78:79]
    v_pk_fma_f32 v[32:33], v[32:33], s[72:73], s[72:73] op_sel:[0,0,1] op_sel_hi:[1,0,1]
    v_pk_fma_f32 v[34:35], v[34:35], s[72:73], s[72:73] op_sel:[0,0,1] op_sel_hi:[1,0,1]
    v_pk_fma_f32 v[36:37], v[36:37], s[72:73], s[72:73] op_sel:[0,0,1] op_sel_hi:[1,0,1]
    v_pk_fma_f32 v[38:39], v[38:39], s[72:73], s[72:73] op_sel:[0,0,1] op_sel_hi:[1,0,1]
    v_pk_mul_f32 v[32:33], v[32:33], v[72:73]
    v_pk_mul_f32 v[34:35], v[34:35], v[74:75]
    v_pk_mul_f32 v[36:37], v[36:37], v[76:77]
    v_pk_mul_f32 v[38:39], v[38:39], v[78:79]
    v_exp_f32 v32, v32
    v_exp_f32 v33, v33
    v_exp_f32 v34, v34
    v_exp_f32 v35, v35
    v_exp_f32 v36, v36
    v_exp_f32 v37, v37
    v_exp_f32 v38, v38
    v_exp_f32 v39, v39
    v_pk_add_f32 v[32:33], v[32:33], 1.0 op_sel_hi:[1,0]
    v_pk_add_f32 v[34:35], v[34:35], 1.0 op_sel_hi:[1,0]
    v_pk_add_f32 v[36:37], v[36:37], 1.0 op_sel_hi:[1,0]
    v_pk_add_f32 v[38:39], v[38:39], 1.0 op_sel_hi:[1,0]
    v_rcp_f32 v32, v32
    v_rcp_f32 v33, v33
    v_rcp_f32 v34, v34
    v_rcp_f32 v35, v35
    v_rcp_f32 v36, v36
    v_rcp_f32 v37, v37
    v_rcp_f32 v38, v38
    v_rcp_f32 v39, v39
    v_pk_mul_f32 v[104:105], v[32:33], v[72:73]
    v_pk_mul_f32 v[106:107], v[34:35], v[74:75]
    v_pk_mul_f32 v[108:109], v[36:37], v[76:77]
    v_pk_mul_f32 v[110:111], v[38:39], v[78:79]
    v_pk_mul_f32 v[32:33], v[80:81], v[80:81]
    v_pk_mul_f32 v[34:35], v[82:83], v[82:83]
    v_pk_mul_f32 v[36:37], v[84:85], v[84:85]
    v_pk_mul_f32 v[38:39], v[86:87], v[86:87]
    v_pk_fma_f32 v[32:33], v[32:33], s[72:73], s[72:73] op_sel:[0,0,1] op_sel_hi:[1,0,1]
    v_pk_fma_f32 v[34:35], v[34:35], s[72:73], s[72:73] op_sel:[0,0,1] op_sel_hi:[1,0,1]
    v_pk_fma_f32 v[36:37], v[36:37], s[72:73], s[72:73] op_sel:[0,0,1] op_sel_hi:[1,0,1]
    v_pk_fma_f32 v[38:39], v[38:39], s[72:73], s[72:73] op_sel:[0,0,1] op_sel_hi:[1,0,1]
    v_pk_mul_f32 v[32:33], v[32:33], v[80:81]
    v_pk_mul_f32 v[34:35], v[34:35], v[82:83]
    v_pk_mul_f32 v[36:37], v[36:37], v[84:85]
    v_pk_mul_f32 v[38:39], v[38:39], v[86:87]
    v_exp_f32 v32, v32
    v_exp_f32 v33, v33
    v_exp_f32 v34, v34
    v_exp_f32 v35, v35
    v_exp_f32 v36, v36
    v_exp_f32 v37, v37
    v_exp_f32 v38, v38
    v_exp_f32 v39, v39
    v_pk_add_f32 v[32:33], v[32:33], 1.0 op_sel_hi:[1,0]
    v_pk_add_f32 v[34:35], v[34:35], 1.0 op_sel_hi:[1,0]
    v_pk_add_f32 v[36:37], v[36:37], 1.0 op_sel_hi:[1,0]
    v_pk_add_f32 v[38:39], v[38:39], 1.0 op_sel_hi:[1,0]
    v_rcp_f32 v32, v32
    v_rcp_f32 v33, v33
    v_rcp_f32 v34, v34
    v_rcp_f32 v35, v35
    v_rcp_f32 v36, v36
    v_rcp_f32 v37, v37
    v_rcp_f32 v38, v38
    v_rcp_f32 v39, v39
    v_pk_mul_f32 v[112:113], v[32:33], v[80:81]
    v_pk_mul_f32 v[114:115], v[34:35], v[82:83]
    v_pk_mul_f32 v[116:117], v[36:37], v[84:85]
    v_pk_mul_f32 v[118:119], v[38:39], v[86:87]
    v_pk_mul_f32 v[32:33], v[88:89], v[88:89]
    v_pk_mul_f32 v[34:35], v[90:91], v[90:91]
    v_pk_mul_f32 v[36:37], v[92:93], v[92:93]
    v_pk_mul_f32 v[38:39], v[94:95], v[94:95]
    v_pk_fma_f32 v[32:33], v[32:33], s[72:73], s[72:73] op_sel:[0,0,1] op_sel_hi:[1,0,1]
    v_pk_fma_f32 v[34:35], v[34:35], s[72:73], s[72:73] op_sel:[0,0,1] op_sel_hi:[1,0,1]
    v_pk_fma_f32 v[36:37], v[36:37], s[72:73], s[72:73] op_sel:[0,0,1] op_sel_hi:[1,0,1]
    v_pk_fma_f32 v[38:39], v[38:39], s[72:73], s[72:73] op_sel:[0,0,1] op_sel_hi:[1,0,1]
    v_pk_mul_f32 v[32:33], v[32:33], v[88:89]
    v_pk_mul_f32 v[34:35], v[34:35], v[90:91]
    v_pk_mul_f32 v[36:37], v[36:37], v[92:93]
    v_pk_mul_f32 v[38:39], v[38:39], v[94:95]
    v_exp_f32 v32, v32
    v_exp_f32 v33, v33
    v_exp_f32 v34, v34
    v_exp_f32 v35, v35
    v_exp_f32 v36, v36
    v_exp_f32 v37, v37
    v_exp_f32 v38, v38
    v_exp_f32 v39, v39
    v_pk_add_f32 v[32:33], v[32:33], 1.0 op_sel_hi:[1,0]
    v_pk_add_f32 v[34:35], v[34:35], 1.0 op_sel_hi:[1,0]
    v_pk_add_f32 v[36:37], v[36:37], 1.0 op_sel_hi:[1,0]
    v_pk_add_f32 v[38:39], v[38:39], 1.0 op_sel_hi:[1,0]
    v_rcp_f32 v32, v32
    v_rcp_f32 v33, v33
    v_rcp_f32 v34, v34
    v_rcp_f32 v35, v35
    v_rcp_f32 v36, v36
    v_rcp_f32 v37, v37
    v_rcp_f32 v38, v38
    v_rcp_f32 v39, v39
    v_pk_mul_f32 v[120:121], v[32:33], v[88:89]
    v_pk_mul_f32 v[122:123], v[34:35], v[90:91]
    v_pk_mul_f32 v[124:125], v[36:37], v[92:93]
    v_pk_mul_f32 v[126:127], v[38:39], v[94:95]
    v_lshlrev_b32 v15, 1, v2
    s_setprio 0
    s_waitcnt lgkmcnt(0)
    s_barrier
    ds_read_b64_tr_b16 v[16:17], v4 offset:24576
    ds_read_b64_tr_b16 v[18:19], v4 offset:24832
    ds_read_b128 v[20:23], v5 offset:24576
    ds_read_b128 v[24:27], v5 offset:28672
    ds_read_b64_tr_b16 v[28:29], v4 offset:25600
    ds_read_b64_tr_b16 v[30:31], v4 offset:25856
    ds_read_b128 v[32:35], v6 offset:24576
    ds_read_b128 v[36:39], v6 offset:28672
    ds_read_b64_tr_b16 v[40:41], v4 offset:26624
    ds_read_b64_tr_b16 v[42:43], v4 offset:26880
    ds_read_b128 v[44:47], v7 offset:24576
    ds_read_b128 v[48:51], v7 offset:28672
    ds_read_b64_tr_b16 v[52:53], v4 offset:27648
    ds_read_b64_tr_b16 v[54:55], v4 offset:27904
    ds_read_b128 v[56:59], v8 offset:24576
    ds_read_b128 v[60:63], v8 offset:28672
    s_waitcnt lgkmcnt(8)
    v_mfma_f32_32x32x16_bf16 v[64:79], v[16:19], v[20:23], 0
    v_mfma_f32_32x32x16_bf16 v[80:95], v[16:19], v[24:27], 0
    v_mfma_f32_32x32x16_bf16 v[64:79], v[28:31], v[32:35], v[64:79]
    v_mfma_f32_32x32x16_bf16 v[80:95], v[28:31], v[36:39], v[80:95]
    s_waitcnt lgkmcnt(0)
    s_barrier
    ds_read_b64_tr_b16 v[16:17], v4 offset:49152
    ds_read_b64_tr_b16 v[18:19], v4 offset:49408
    ds_read_b128 v[20:23], v5 offset:49152
    ds_read_b128 v[24:27], v5 offset:53248
    ds_read_b64_tr_b16 v[28:29], v4 offset:50176
    ds_read_b64_tr_b16 v[30:31], v4 offset:50432
    ds_read_b128 v[32:35], v6 offset:49152
    ds_read_b128 v[36:39], v6 offset:53248
    v_mfma_f32_32x32x16_bf16 v[64:79], v[40:43], v[44:47], v[64:79]
    v_mfma_f32_32x32x16_bf16 v[80:95], v[40:43], v[48:51], v[80:95]
    v_mfma_f32_32x32x16_bf16 v[64:79], v[52:55], v[56:59], v[64:79]
    v_mfma_f32_32x32x16_bf16 v[80:95], v[52:55], v[60:63], v[80:95]
    ds_read_b64_tr_b16 v[40:41], v4 offset:51200
    ds_read_b64_tr_b16 v[42:43], v4 offset:51456
    ds_read_b128 v[44:47], v7 offset:49152
    ds_read_b128 v[48:51], v7 offset:53248
    ds_read_b64_tr_b16 v[52:53], v4 offset:52224
    ds_read_b64_tr_b16 v[54:55], v4 offset:52480
    ds_read_b128 v[56:59], v8 offset:49152
    ds_read_b128 v[60:63], v8 offset:53248
    s_waitcnt lgkmcnt(8)
    v_mfma_f32_32x32x16_bf16 v[64:79], v[16:19], v[20:23], v[64:79]
    v_mfma_f32_32x32x16_bf16 v[80:95], v[16:19], v[24:27], v[80:95]
    v_mfma_f32_32x32x16_bf16 v[64:79], v[28:31], v[32:35], v[64:79]
    v_mfma_f32_32x32x16_bf16 v[80:95], v[28:31], v[36:39], v[80:95]
    s_mov_b32 s53, 0
.p2align 3
kf_gloop:
    s_waitcnt lgkmcnt(0)
    s_barrier
    ds_read_b64_tr_b16 v[16:17], v4 offset:0
    ds_read_b64_tr_b16 v[18:19], v4 offset:256
    ds_read_b128 v[20:23], v5 offset:0
    ds_read_b128 v[24:27], v5 offset:4096
    ds_read_b64_tr_b16 v[28:29], v4 offset:1024
    ds_read_b64_tr_b16 v[30:31], v4 offset:1280
    ds_read_b128 v[32:35], v6 offset:0
    ds_read_b128 v[36:39], v6 offset:4096
    v_mfma_f32_32x32x16_bf16 v[64:79], v[40:43], v[44:47], v[64:79]
    v_mfma_f32_32x32x16_bf16 v[80:95], v[40:43], v[48:51], v[80:95]
    v_mfma_f32_32x32x16_bf16 v[64:79], v[52:55], v[56:59], v[64:79]
    v_mfma_f32_32x32x16_bf16 v[80:95], v[52:55], v[60:63], v[80:95]
    ds_read_b64_tr_b16 v[40:41], v4 offset:2048
    ds_read_b64_tr_b16 v[42:43], v4 offset:2304
    ds_read_b128 v[44:47], v7 offset:0
    ds_read_b128 v[48:51], v7 offset:4096
    ds_read_b64_tr_b16 v[52:53], v4 offset:3072
    ds_read_b64_tr_b16 v[54:55], v4 offset:3328
    ds_read_b128 v[56:59], v8 offset:0
    ds_read_b128 v[60:63], v8 offset:4096
    s_waitcnt lgkmcnt(8)
    v_mfma_f32_32x32x16_bf16 v[64:79], v[16:19], v[20:23], v[64:79]
    v_mfma_f32_32x32x16_bf16 v[80:95], v[16:19], v[24:27], v[80:95]
    v_mfma_f32_32x32x16_bf16 v[64:79], v[28:31], v[32:35], v[64:79]
    v_mfma_f32_32x32x16_bf16 v[80:95], v[28:31], v[36:39], v[80:95]
    s_waitcnt lgkmcnt(0)
    s_barrier
    ds_read_b64_tr_b16 v[16:17], v4 offset:24576
    ds_read_b64_tr_b16 v[18:19], v4 offset:24832
    ds_read_b128 v[20:23], v5 offset:24576
    ds_read_b128 v[24:27], v5 offset:28672
    ds_read_b64_tr_b16 v[28:29], v4 offset:25600
    ds_read_b64_tr_b16 v[30:31], v4 offset:25856
    ds_read_b128 v[32:35], v6 offset:24576
    ds_read_b128 v[36:39], v6 offset:28672
    v_mfma_f32_32x32x16_bf16 v[64:79], v[40:43], v[44:47], v[64:79]
    v_mfma_f32_32x32x16_bf16 v[80:95], v[40:43], v[48:51], v[80:95]
    v_mfma_f32_32x32x16_bf16 v[64:79], v[52:55], v[56:59], v[64:79]
    v_mfma_f32_32x32x16_bf16 v[80:95], v[52:55], v[60:63], v[80:95]
    ds_read_b64_tr_b16 v[40:41], v4 offset:26624
    ds_read_b64_tr_b16 v[42:43], v4 offset:26880
    ds_read_b128 v[44:47], v7 offset:24576
    ds_read_b128 v[48:51], v7 offset:28672
    ds_read_b64_tr_b16 v[52:53], v4 offset:27648
    ds_read_b64_tr_b16 v[54:55], v4 offset:27904
    ds_read_b128 v[56:59], v8 offset:24576
    ds_read_b128 v[60:63], v8 offset:28672
    s_waitcnt lgkmcnt(8)
    v_mfma_f32_32x32x16_bf16 v[64:79], v[16:19], v[20:23], v[64:79]
    v_mfma_f32_32x32x16_bf16 v[80:95], v[16:19], v[24:27], v[80:95]
    v_mfma_f32_32x32x16_bf16 v[64:79], v[28:31], v[32:35], v[64:79]
    v_mfma_f32_32x32x16_bf16 v[80:95], v[28:31], v[36:39], v[80:95]
    s_waitcnt lgkmcnt(0)
    s_barrier
    ds_read_b64_tr_b16 v[16:17], v4 offset:49152
    ds_read_b64_tr_b16 v[18:19], v4 offset:49408
    ds_read_b128 v[20:23], v5 offset:49152
    ds_read_b128 v[24:27], v5 offset:53248
    ds_read_b64_tr_b16 v[28:29], v4 offset:50176
    ds_read_b64_tr_b16 v[30:31], v4 offset:50432
    ds_read_b128 v[32:35], v6 offset:49152
    ds_read_b128 v[36:39], v6 offset:53248
    v_mfma_f32_32x32x16_bf16 v[64:79], v[40:43], v[44:47], v[64:79]
    v_mfma_f32_32x32x16_bf16 v[80:95], v[40:43], v[48:51], v[80:95]
    v_mfma_f32_32x32x16_bf16 v[64:79], v[52:55], v[56:59], v[64:79]
    v_mfma_f32_32x32x16_bf16 v[80:95], v[52:55], v[60:63], v[80:95]
    ds_read_b64_tr_b16 v[40:41], v4 offset:51200
    ds_read_b64_tr_b16 v[42:43], v4 offset:51456
    ds_read_b128 v[44:47], v7 offset:49152
    ds_read_b128 v[48:51], v7 offset:53248
    ds_read_b64_tr_b16 v[52:53], v4 offset:52224
    ds_read_b64_tr_b16 v[54:55], v4 offset:52480
    ds_read_b128 v[56:59], v8 offset:49152
    ds_read_b128 v[60:63], v8 offset:53248
    s_waitcnt lgkmcnt(8)
    v_mfma_f32_32x32x16_bf16 v[64:79], v[16:19], v[20:23], v[64:79]
    v_mfma_f32_32x32x16_bf16 v[80:95], v[16:19], v[24:27], v[80:95]
    v_mfma_f32_32x32x16_bf16 v[64:79], v[28:31], v[32:35], v[64:79]
    v_mfma_f32_32x32x16_bf16 v[80:95], v[28:31], v[36:39], v[80:95]
    s_add_u32 s53, s53, 1
    s_cmp_lt_u32 s53, 9
    s_cbranch_scc1 kf_gloop
    buffer_load_ushort v10, v15, s[28:31], s52 offen offset:0
    buffer_load_ushort v14, v15, s[28:31], s52 offen offset:64
    s_waitcnt lgkmcnt(0)
    s_barrier
    ds_read_b64_tr_b16 v[16:17], v4 offset:0
    ds_read_b64_tr_b16 v[18:19], v4 offset:256
    ds_read_b128 v[20:23], v5 offset:0
    ds_read_b128 v[24:27], v5 offset:4096
    ds_read_b64_tr_b16 v[28:29], v4 offset:1024
    ds_read_b64_tr_b16 v[30:31], v4 offset:1280
    ds_read_b128 v[32:35], v6 offset:0
    ds_read_b128 v[36:39], v6 offset:4096
    v_mfma_f32_32x32x16_bf16 v[64:79], v[40:43], v[44:47], v[64:79]
    v_mfma_f32_32x32x16_bf16 v[80:95], v[40:43], v[48:51], v[80:95]
    v_mfma_f32_32x32x16_bf16 v[64:79], v[52:55], v[56:59], v[64:79]
    v_mfma_f32_32x32x16_bf16 v[80:95], v[52:55], v[60:63], v[80:95]
    ds_read_b64_tr_b16 v[40:41], v4 offset:2048
    ds_read_b64_tr_b16 v[42:43], v4 offset:2304
    ds_read_b128 v[44:47], v7 offset:0
    ds_read_b128 v[48:51], v7 offset:4096
    ds_read_b64_tr_b16 v[52:53], v4 offset:3072
    ds_read_b64_tr_b16 v[54:55], v4 offset:3328
    ds_read_b128 v[56:59], v8 offset:0
    ds_read_b128 v[60:63], v8 offset:4096
    s_waitcnt lgkmcnt(8)
    v_mfma_f32_32x32x16_bf16 v[64:79], v[16:19], v[20:23], v[64:79]
    v_mfma_f32_32x32x16_bf16 v[80:95], v[16:19], v[24:27], v[80:95]
    v_mfma_f32_32x32x16_bf16 v[64:79], v[28:31], v[32:35], v[64:79]
    v_mfma_f32_32x32x16_bf16 v[80:95], v[28:31], v[36:39], v[80:95]
    s_waitcnt lgkmcnt(0)
    s_barrier
    ds_read_b64_tr_b16 v[16:17], v4 offset:24576
    ds_read_b64_tr_b16 v[18:19], v4 offset:24832
    ds_read_b128 v[20:23], v5 offset:24576
    ds_read_b128 v[24:27], v5 offset:28672
    ds_read_b64_tr_b16 v[28:29], v4 offset:25600
    ds_read_b64_tr_b16 v[30:31], v4 offset:25856
    ds_read_b128 v[32:35], v6 offset:24576
    ds_read_b128 v[36:39], v6 offset:28672
    v_mfma_f32_32x32x16_bf16 v[64:79], v[40:43], v[44:47], v[64:79]
    v_mfma_f32_32x32x16_bf16 v[80:95], v[40:43], v[48:51], v[80:95]
    v_mfma_f32_32x32x16_bf16 v[64:79], v[52:55], v[56:59], v[64:79]
    v_mfma_f32_32x32x16_bf16 v[80:95], v[52:55], v[60:63], v[80:95]
    ds_read_b64_tr_b16 v[40:41], v4 offset:26624
    ds_read_b64_tr_b16 v[42:43], v4 offset:26880
    ds_read_b128 v[44:47], v7 offset:24576
    ds_read_b128 v[48:51], v7 offset:28672
    ds_read_b64_tr_b16 v[52:53], v4 offset:27648
    ds_read_b64_tr_b16 v[54:55], v4 offset:27904
    ds_read_b128 v[56:59], v8 offset:24576
    ds_read_b128 v[60:63], v8 offset:28672
    s_waitcnt lgkmcnt(8)
    v_mfma_f32_32x32x16_bf16 v[64:79], v[16:19], v[20:23], v[64:79]
    v_mfma_f32_32x32x16_bf16 v[80:95], v[16:19], v[24:27], v[80:95]
    v_mfma_f32_32x32x16_bf16 v[64:79], v[28:31], v[32:35], v[64:79]
    v_mfma_f32_32x32x16_bf16 v[80:95], v[28:31], v[36:39], v[80:95]
    s_waitcnt lgkmcnt(0)
    s_barrier
    ds_read_b64_tr_b16 v[16:17], v4 offset:49152
    ds_read_b64_tr_b16 v[18:19], v4 offset:49408
    ds_read_b128 v[20:23], v5 offset:49152
    ds_read_b128 v[24:27], v5 offset:53248
    ds_read_b64_tr_b16 v[28:29], v4 offset:50176
    ds_read_b64_tr_b16 v[30:31], v4 offset:50432
    ds_read_b128 v[32:35], v6 offset:49152
    ds_read_b128 v[36:39], v6 offset:53248
    v_mfma_f32_32x32x16_bf16 v[64:79], v[40:43], v[44:47], v[64:79]
    v_mfma_f32_32x32x16_bf16 v[80:95], v[40:43], v[48:51], v[80:95]
    v_mfma_f32_32x32x16_bf16 v[64:79], v[52:55], v[56:59], v[64:79]
    v_mfma_f32_32x32x16_bf16 v[80:95], v[52:55], v[60:63], v[80:95]
    ds_read_b64_tr_b16 v[40:41], v4 offset:51200
    ds_read_b64_tr_b16 v[42:43], v4 offset:51456
    ds_read_b128 v[44:47], v7 offset:49152
    ds_read_b128 v[48:51], v7 offset:53248
    ds_read_b64_tr_b16 v[52:53], v4 offset:52224
    ds_read_b64_tr_b16 v[54:55], v4 offset:52480
    ds_read_b128 v[56:59], v8 offset:49152
    ds_read_b128 v[60:63], v8 offset:53248
    s_waitcnt lgkmcnt(8)
    v_mfma_f32_32x32x16_bf16 v[64:79], v[16:19], v[20:23], v[64:79]
    v_mfma_f32_32x32x16_bf16 v[80:95], v[16:19], v[24:27], v[80:95]
    v_mfma_f32_32x32x16_bf16 v[64:79], v[28:31], v[32:35], v[64:79]
    v_mfma_f32_32x32x16_bf16 v[80:95], v[28:31], v[36:39], v[80:95]
    s_waitcnt lgkmcnt(0)
    s_setprio 2
    v_mfma_f32_32x32x16_bf16 v[64:79], v[40:43], v[44:47], v[64:79]
    v_mfma_f32_32x32x16_bf16 v[80:95], v[40:43], v[48:51], v[80:95]
    v_mfma_f32_32x32x16_bf16 v[64:79], v[52:55], v[56:59], v[64:79]
    v_mfma_f32_32x32x16_bf16 v[80:95], v[52:55], v[60:63], v[80:95]
    s_waitcnt vmcnt(0)
    v_lshlrev_b32 v10, 16, v10
    v_lshlrev_b32 v14, 16, v14
    s_nop 7
    v_pk_add_f32 v[64:65], v[64:65], v[10:11] op_sel_hi:[1,0]
    v_pk_add_f32 v[66:67], v[66:67], v[10:11] op_sel_hi:[1,0]
    v_pk_add_f32 v[68:69], v[68:69], v[10:11] op_sel_hi:[1,0]
    v_pk_add_f32 v[70:71], v[70:71], v[10:11] op_sel_hi:[1,0]
    v_pk_mul_f32 v[64:65], v[64:65], v[96:97]
    v_pk_mul_f32 v[66:67], v[66:67], v[98:99]
    v_pk_mul_f32 v[68:69], v[68:69], v[100:101]
    v_pk_mul_f32 v[70:71], v[70:71], v[102:103]
    v_cvt_pk_bf16_f32 v16, v64, v65
    v_cvt_pk_bf16_f32 v17, v66, v67
    v_cvt_pk_bf16_f32 v18, v68, v69
    v_cvt_pk_bf16_f32 v19, v70, v71
    buffer_store_dwordx4 v[16:19], v9, s[12:15], s50 offen offset:0 sc1
    v_pk_add_f32 v[72:73], v[72:73], v[10:11] op_sel_hi:[1,0]
    v_pk_add_f32 v[74:75], v[74:75], v[10:11] op_sel_hi:[1,0]
    v_pk_add_f32 v[76:77], v[76:77], v[10:11] op_sel_hi:[1,0]
    v_pk_add_f32 v[78:79], v[78:79], v[10:11] op_sel_hi:[1,0]
    v_pk_mul_f32 v[72:73], v[72:73], v[104:105]
    v_pk_mul_f32 v[74:75], v[74:75], v[106:107]
    v_pk_mul_f32 v[76:77], v[76:77], v[108:109]
    v_pk_mul_f32 v[78:79], v[78:79], v[110:111]
    v_cvt_pk_bf16_f32 v20, v72, v73
    v_cvt_pk_bf16_f32 v21, v74, v75
    v_cvt_pk_bf16_f32 v22, v76, v77
    v_cvt_pk_bf16_f32 v23, v78, v79
    buffer_store_dwordx4 v[20:23], v9, s[12:15], s50 offen offset:1024 sc1
    v_pk_add_f32 v[80:81], v[80:81], v[14:15] op_sel_hi:[1,0]
    v_pk_add_f32 v[82:83], v[82:83], v[14:15] op_sel_hi:[1,0]
    v_pk_add_f32 v[84:85], v[84:85], v[14:15] op_sel_hi:[1,0]
    v_pk_add_f32 v[86:87], v[86:87], v[14:15] op_sel_hi:[1,0]
    v_pk_mul_f32 v[80:81], v[80:81], v[112:113]
    v_pk_mul_f32 v[82:83], v[82:83], v[114:115]
    v_pk_mul_f32 v[84:85], v[84:85], v[116:117]
    v_pk_mul_f32 v[86:87], v[86:87], v[118:119]
    v_cvt_pk_bf16_f32 v24, v80, v81
    v_cvt_pk_bf16_f32 v25, v82, v83
    v_cvt_pk_bf16_f32 v26, v84, v85
    v_cvt_pk_bf16_f32 v27, v86, v87
    buffer_store_dwordx4 v[24:27], v9, s[12:15], s55 offen offset:0 sc1
    v_pk_add_f32 v[88:89], v[88:89], v[14:15] op_sel_hi:[1,0]
    v_pk_add_f32 v[90:91], v[90:91], v[14:15] op_sel_hi:[1,0]
    v_pk_add_f32 v[92:93], v[92:93], v[14:15] op_sel_hi:[1,0]
    v_pk_add_f32 v[94:95], v[94:95], v[14:15] op_sel_hi:[1,0]
    v_pk_mul_f32 v[88:89], v[88:89], v[120:121]
    v_pk_mul_f32 v[90:91], v[90:91], v[122:123]
    v_pk_mul_f32 v[92:93], v[92:93], v[124:125]
    v_pk_mul_f32 v[94:95], v[94:95], v[126:127]
    v_cvt_pk_bf16_f32 v28, v88, v89
    v_cvt_pk_bf16_f32 v29, v90, v91
    v_cvt_pk_bf16_f32 v30, v92, v93
    v_cvt_pk_bf16_f32 v31, v94, v95
    buffer_store_dwordx4 v[28:31], v9, s[12:15], s55 offen offset:1024 sc1
    s_barrier
    s_branch k2_out1
kf_gh:
    s_lshl_b32 s40, s35, 19
    s_add_u32 s40, s40, 14680064
    s_and_b32 s46, s38, 3
    v_lshlrev_b32 v4, 17, v3
    v_lshl_add_u32 v4, v2, 7, v4
    v_lshlrev_b32 v5, 2, v1
    v_lshlrev_b32 v6, 3, v1
    v_add_u32 v7, 73728, v5
    v_lshlrev_b32 v5, 2, v2
    s_lshl_b32 s47, s56, 12
    s_add_u32 s47, s47, 18874368
    s_lshl_b32 s48, s57, 9
    s_add_u32 s48, s48, s47
    s_lshl_b32 s49, s57, 7
    s_mul_i32 s51, s56, 8320
    s_add_u32 s51, s51, s49
    s_add_u32 s51, s51, 19404800
    s_lshl_b32 s49, s35, 7
    s_add_u32 s49, s49, 19404800
    s_mul_i32 s58, s38, 8320
    s_add_u32 s58, s58, s49
    s_add_u32 s58, s58, 896
    v_mul_u32_u24 v14, 8320, v2
    v_mov_b32 v30, 1
    v_mov_b32 v31, 0
    s_lshl_b32 s51, s57, 7
    s_lshl_b32 s44, s56, 2
    s_add_u32 s51, s51, s44
    s_add_u32 s51, s51, 19404800
    s_mul_i32 s44, s38, 8320
    s_add_u32 s49, s49, s44
    s_lshl_b32 s50, s38, 3
    s_add_u32 s50, s50, s35
    s_lshl_b32 s50, s50, 15
    v_lshlrev_b32 v12, 7, v1
    s_setprio 2
    v_lshrrev_b32 v15, 1, v1
    v_mul_u32_u24 v15, 3584, v15
    v_and_b32 v13, 1, v1
    v_lshl_add_u32 v15, v13, 7, v15
    s_lshl_b32 s52, s57, 8
    s_add_u32 s52, s52, 1792
    s_lshl_b32 s59, s35, 8
    s_waitcnt lgkmcnt(0)
    s_sleep 40
    s_add_u32 s53, s75, 0
    s_and_b32 s53, s53, 7
    s_mul_i32 s45, s53, 229376
    s_add_u32 s45, s45, s52
    buffer_load_dword v13, v15, s[20:23], s45 offen
    s_add_u32 s45, s45, 114688
    buffer_load_dword v13, v15, s[20:23], s45 offen
    s_cmp_lt_u32 s34, 24
    s_cbranch_scc1 kf_t1
    s_add_u32 s53, s75, 1
    s_and_b32 s53, s53, 7
    s_mul_i32 s45, s53, 229376
    s_add_u32 s45, s45, s52
    buffer_load_dword v13, v15, s[20:23], s45 offen
    s_add_u32 s45, s45, 114688
    buffer_load_dword v13, v15, s[20:23], s45 offen
kf_t1:
    s_barrier
    s_barrier
    s_barrier
    s_barrier
    s_barrier
    s_barrier
    buffer_load_dword v9, v5, s[24:27], 0 offen sc1
    s_barrier
    s_barrier
    s_waitcnt vmcnt(0)
    v_cmp_ne_u32 vcc, 1, v9
    s_cbranch_vccz kf_hrd_done
    s_mov_b64 exec, -1
    s_mov_b32 s53, 0
kf_hrd:
    buffer_load_dword v10, v5, s[24:27], 0 offen sc1
    s_add_u32 s53, s53, 1
    s_waitcnt vmcnt(0)
    v_cmp_ne_u32 vcc, 1, v10
    s_cbranch_vccz kf_hrd_done
    s_sleep 4
    s_cmp_lt_u32 s53, 131072
    s_cbranch_scc1 kf_hrd
kf_hrd_done:
    s_mov_b64 exec, -1
    s_waitcnt vmcnt(0)
    s_barrier
    ds_read2st64_b32 v[16:17], v7 offset0:0 offset1:1
    ds_read2st64_b32 v[18:19], v7 offset0:2 offset1:3
    ds_read2st64_b32 v[20:21], v7 offset0:4 offset1:5
    ds_read2st64_b32 v[22:23], v7 offset0:6 offset1:7
    s_waitcnt lgkmcnt(0)
    v_pk_add_f32 v[16:17], v[16:17], v[18:19]
    v_pk_add_f32 v[20:21], v[20:21], v[22:23]
    v_pk_add_f32 v[16:17], v[16:17], v[20:21]
    buffer_store_dwordx2 v[16:17], v6, s[12:15], s48 offen sc1
    s_barrier
    s_barrier
    s_barrier
    buffer_load_dwordx2 v[16:17], v6, s[12:15], s47 offen offset:0 sc1
    buffer_load_dwordx2 v[18:19], v6, s[12:15], s47 offen offset:512 sc1
    buffer_load_dwordx2 v[20:21], v6, s[12:15], s47 offen offset:1024 sc1
    buffer_load_dwordx2 v[22:23], v6, s[12:15], s47 offen offset:1536 sc1
    buffer_load_dwordx2 v[24:25], v6, s[12:15], s47 offen offset:2048 sc1
    buffer_load_dwordx2 v[26:27], v6, s[12:15], s47 offen offset:2560 sc1
    buffer_load_dwordx2 v[28:29], v6, s[12:15], s47 offen offset:3072 sc1
    s_mov_b32 s53, 0
kf_hst:
    s_waitcnt vmcnt(0)
    v_max3_u32 v8, v16, v17, v18
    v_max3_u32 v8, v8, v19, v20
    v_max3_u32 v8, v8, v21, v22
    v_max3_u32 v8, v8, v23, v24
    v_max3_u32 v8, v8, v25, v26
    v_max3_u32 v8, v8, v27, v28
    v_max_u32 v8, v8, v29
    v_cmp_eq_u32 vcc, -1, v8
    s_add_u32 s53, s53, 1
    s_cmp_ge_u32 s53, 0x20000
    s_cbranch_scc1 kf_hsd
    s_cbranch_vccz kf_hsd
    s_sleep 6
    buffer_load_dwordx2 v[16:17], v6, s[12:15], s47 offen offset:0 sc1
    buffer_load_dwordx2 v[18:19], v6, s[12:15], s47 offen offset:512 sc1
    buffer_load_dwordx2 v[20:21], v6, s[12:15], s47 offen offset:1024 sc1
    buffer_load_dwordx2 v[22:23], v6, s[12:15], s47 offen offset:1536 sc1
    buffer_load_dwordx2 v[24:25], v6, s[12:15], s47 offen offset:2048 sc1
    buffer_load_dwordx2 v[26:27], v6, s[12:15], s47 offen offset:2560 sc1
    buffer_load_dwordx2 v[28:29], v6, s[12:15], s47 offen offset:3072 sc1
    s_branch kf_hst
kf_hsd:
    v_pk_add_f32 v[16:17], v[16:17], v[18:19]
    v_pk_add_f32 v[16:17], v[16:17], v[20:21]
    v_pk_add_f32 v[16:17], v[16:17], v[22:23]
    v_pk_add_f32 v[16:17], v[16:17], v[24:25]
    v_pk_add_f32 v[16:17], v[16:17], v[26:27]
    v_pk_add_f32 v[16:17], v[16:17], v[28:29]
    v_mul_f32 v16, 0x3a924925, v16
    v_mul_f32 v17, 0x3a924925, v17
    v_mov_b32 v18, v16
    v_mov_b32 v19, v17
    s_nop 1
    v_permlane32_swap_b32 v16, v18
    v_permlane32_swap_b32 v17, v19
    s_nop 1
    v_fma_f32 v18, -v16, v16, v18
    v_fma_f32 v19, -v17, v17, v19
    v_max_f32 v18, 0, v18
    v_max_f32 v19, 0, v19
    v_add_f32 v18, 0x3727c5ac, v18
    v_add_f32 v19, 0x3727c5ac, v19
    v_rsq_f32 v20, v18
    v_rsq_f32 v22, v19
    v_lshlrev_b32 v8, 4, v2
    v_add_u32 v8, 75776, v8
    v_mul_f32_e64 v21, -v16, v20
    v_mul_f32_e64 v23, -v17, v22
    ds_write_b128 v8, v[20:23]
    s_waitcnt lgkmcnt(0)
    s_barrier
    s_barrier
    s_barrier
    s_mov_b64 exec, 0xffffffff
    buffer_store_dword v30, v14, s[12:15], s51 offen sc1
    s_mov_b64 exec, -1
    s_barrier
    s_mov_b32 s53, 0
    s_add_u32 s36, s49, s12
    s_addc_u32 s37, s13, 0
    s_barrier
    s_load_dwordx16 s[16:31], s[36:37], 0 glc
    s_barrier
    s_barrier
    s_waitcnt lgkmcnt(0)
    s_or_b64 s[44:45], s[16:17], s[18:19]
    s_or_b64 s[44:45], s[44:45], s[20:21]
    s_or_b64 s[44:45], s[44:45], s[22:23]
    s_or_b64 s[44:45], s[44:45], s[24:25]
    s_or_b64 s[44:45], s[44:45], s[26:27]
    s_or_b64 s[44:45], s[44:45], s[28:29]
    s_or_b64 s[44:45], s[44:45], s[30:31]
    s_load_dwordx16 s[16:31], s[36:37], 64 glc
    s_barrier
    s_barrier
    s_barrier
    s_waitcnt lgkmcnt(0)
    s_or_b64 s[44:45], s[44:45], s[16:17]
    s_or_b64 s[44:45], s[44:45], s[18:19]
    s_or_b64 s[44:45], s[44:45], s[20:21]
    s_or_b64 s[44:45], s[44:45], s[22:23]
    s_or_b64 s[44:45], s[44:45], s[24:25]
    s_or_b64 s[44:45], s[44:45], s[26:27]
    s_or_b64 s[44:45], s[44:45], s[28:29]
    s_or_b64 s[44:45], s[44:45], s[30:31]
    s_or_b32 s44, s44, s45
    s_cmp_eq_u32 s44, 1
    s_cbranch_scc1 kf_poll_done
    s_mov_b64 exec, 0xffffffff
kf_poll:
    buffer_load_dword v8, v5, s[12:15], s49 offen sc1
    s_add_u32 s53, s53, 1
    s_waitcnt vmcnt(0)
    v_cmp_ne_u32 vcc, 1, v8
    s_cmp_ge_u32 s53, 0x40000
    s_cbranch_scc1 kf_poll_done
    s_cbranch_vccz kf_poll_done
    s_sleep 8
    s_branch kf_poll
kf_poll_done:
    s_mov_b64 exec, -1
    s_and_b32 s46, s46, 3
    s_mul_i32 s46, s46, 1
    s_barrier
    s_barrier
    s_barrier
    s_barrier
    s_barrier
    s_barrier
    s_barrier
    s_barrier
    s_barrier
    s_barrier
    s_barrier
    s_barrier
    s_barrier
    s_barrier
    s_barrier
    s_barrier
    s_mul_i32 s58, s38, 8320
    s_add_u32 s58, s58, 19402752
    buffer_load_dword v9, v31, s[12:15], s58 offen sc1
    s_lshl_b32 s44, s34, 15
    s_mul_i32 s45, s34, 24576
    v_lshlrev_b32 v4, 7, v1
    v_add_u32 v5, s45, v4
    buffer_load_dword v10, v4, s[64:67], s44 offen
    s_add_u32 s44, s44, 8192
    buffer_load_dword v10, v4, s[64:67], s44 offen
    s_add_u32 s44, s44, 8192
    buffer_load_dword v10, v4, s[64:67], s44 offen
    s_add_u32 s44, s44, 8192
    buffer_load_dword v10, v4, s[64:67], s44 offen
    s_add_u32 s44, s44, 8192
    buffer_load_dword v10, v5, s[68:71], 0 offen
    v_add_u32 v5, 8192, v5
    buffer_load_dword v10, v5, s[68:71], 0 offen
    v_add_u32 v5, 8192, v5
    buffer_load_dword v10, v5, s[68:71], 0 offen
    v_add_u32 v5, 8192, v5
    s_barrier
    s_barrier
    s_barrier
    s_barrier
    s_barrier
    s_waitcnt vmcnt(7)
    v_cmp_ne_u32 vcc, 1, v9
    s_cbranch_vccz kf_pz1_done
    s_mov_b64 exec, 1
    s_mov_b32 s53, 0
kf_pz1:
    buffer_load_dword v10, v31, s[12:15], s58 offen sc1
    s_add_u32 s53, s53, 1
    s_waitcnt vmcnt(0)
    v_cmp_ne_u32 vcc, 1, v10
    s_cbranch_vccz kf_pz1_done
    s_sleep 8
    s_cmp_lt_u32 s53, 131072
    s_cbranch_scc1 kf_pz1
kf_pz1_done:
    s_mov_b64 exec, -1
    s_barrier
    s_barrier
    s_barrier
    s_branch k2_pre
k2_pre:
    s_sub_u32 s44, s32, 4
    s_lshl_b32 s42, s44, 12
    s_lshl_b32 s40, s42, 3
    s_lshl_b32 s46, s35, 7
    s_add_u32 s40, s40, s46
    v_lshrrev_b32 v126, 3, v1
    v_and_b32 v7, 7, v1
    v_bfe_u32 v8, v1, 4, 1
    v_lshlrev_b32 v8, 2, v8
    v_xor_b32 v7, v7, v8
    v_lshlrev_b32 v7, 4, v7
    v_lshl_add_u32 v5, v126, 10, v7
    s_add_u32 s56, s35, 1
    s_cmp_ge_u32 s56, 7
    s_cselect_b32 s44, 7, 0
    s_sub_u32 s56, s56, s44
    s_add_u32 s57, s56, 1
    s_cmp_ge_u32 s57, 7
    s_cselect_b32 s44, 7, 0
    s_sub_u32 s57, s57, s44
    s_add_u32 s58, s57, 1
    s_cmp_ge_u32 s58, 7
    s_cselect_b32 s44, 7, 0
    s_sub_u32 s58, s58, s44
    s_add_u32 s59, s58, 1
    s_cmp_ge_u32 s59, 7
    s_cselect_b32 s44, 7, 0
    s_sub_u32 s59, s59, s44
    s_add_u32 s60, s59, 1
    s_cmp_ge_u32 s60, 7
    s_cselect_b32 s44, 7, 0
    s_sub_u32 s60, s60, s44
    s_add_u32 s61, s60, 1
    s_cmp_ge_u32 s61, 7
    s_cselect_b32 s44, 7, 0
    s_sub_u32 s61, s61, s44
    s_add_u32 s62, s61, 1
    s_cmp_ge_u32 s62, 7
    s_cselect_b32 s44, 7, 0
    s_sub_u32 s62, s62, s44
    s_lshl_b32 s56, s56, 13
    s_lshl_b32 s57, s57, 13
    s_lshl_b32 s58, s58, 13
    s_lshl_b32 s59, s59, 13
    s_lshl_b32 s60, s60, 13
    s_lshl_b32 s61, s61, 13
    s_lshl_b32 s62, s62, 13
    s_waitcnt vmcnt(8)
    s_barrier
    s_lshl_b32 s43, s56, 4
    s_add_u32 s43, s43, s40
    s_add_u32 m0, s42, 0
    s_add_u32 s41, s43, 0
    buffer_load_dwordx4 v5, s[64:67], s41 offen lds
    s_add_u32 m0, s42, 1024
    s_add_u32 s41, s43, 8192
    buffer_load_dwordx4 v5, s[64:67], s41 offen lds
    s_add_u32 m0, s42, 2048
    s_add_u32 s41, s43, 16384
    buffer_load_dwordx4 v5, s[64:67], s41 offen lds
    s_add_u32 m0, s42, 3072
    s_add_u32 s41, s43, 24576
    buffer_load_dwordx4 v5, s[64:67], s41 offen lds
    s_waitcnt vmcnt(4)
    s_barrier
    s_lshl_b32 s43, s57, 4
    s_add_u32 s43, s43, s40
    s_add_u32 m0, s42, 16384
    s_add_u32 s41, s43, 0
    buffer_load_dwordx4 v5, s[64:67], s41 offen lds
    s_add_u32 m0, s42, 17408
    s_add_u32 s41, s43, 8192
    buffer_load_dwordx4 v5, s[64:67], s41 offen lds
    s_add_u32 m0, s42, 18432
    s_add_u32 s41, s43, 16384
    buffer_load_dwordx4 v5, s[64:67], s41 offen lds
    s_add_u32 m0, s42, 19456
    s_add_u32 s41, s43, 24576
    buffer_load_dwordx4 v5, s[64:67], s41 offen lds
    s_lshl_b32 s43, s58, 4
    s_add_u32 s43, s43, s40
    s_add_u32 m0, s42, 32768
    s_add_u32 s41, s43, 0
    buffer_load_dwordx4 v5, s[64:67], s41 offen lds
    s_add_u32 m0, s42, 33792
    s_add_u32 s41, s43, 8192
    buffer_load_dwordx4 v5, s[64:67], s41 offen lds
    s_add_u32 m0, s42, 34816
    s_add_u32 s41, s43, 16384
    buffer_load_dwordx4 v5, s[64:67], s41 offen lds
    s_add_u32 m0, s42, 35840
    s_add_u32 s41, s43, 24576
    buffer_load_dwordx4 v5, s[64:67], s41 offen lds
    s_waitcnt vmcnt(0)
    s_barrier
    s_lshl_b32 s43, s59, 4
    s_add_u32 s43, s43, s40
    s_add_u32 m0, s42, 49152
    s_add_u32 s41, s43, 0
    buffer_load_dwordx4 v5, s[64:67], s41 offen lds
    s_add_u32 m0, s42, 50176
    s_add_u32 s41, s43, 8192
    buffer_load_dwordx4 v5, s[64:67], s41 offen lds
    s_add_u32 m0, s42, 51200
    s_add_u32 s41, s43, 16384
    buffer_load_dwordx4 v5, s[64:67], s41 offen lds
    s_add_u32 m0, s42, 52224
    s_add_u32 s41, s43, 24576
    buffer_load_dwordx4 v5, s[64:67], s41 offen lds
    s_lshl_b32 s43, s60, 4
    s_add_u32 s43, s43, s40
    s_add_u32 m0, s42, 65536
    s_add_u32 s41, s43, 0
    buffer_load_dwordx4 v5, s[64:67], s41 offen lds
    s_add_u32 m0, s42, 66560
    s_add_u32 s41, s43, 8192
    buffer_load_dwordx4 v5, s[64:67], s41 offen lds
    s_add_u32 m0, s42, 67584
    s_add_u32 s41, s43, 16384
    buffer_load_dwordx4 v5, s[64:67], s41 offen lds
    s_add_u32 m0, s42, 68608
    s_add_u32 s41, s43, 24576
    buffer_load_dwordx4 v5, s[64:67], s41 offen lds
    s_branch k2_out2
k2_out1:
    s_add_u32 s56, s35, 1
    s_cmp_ge_u32 s56, 7
    s_cselect_b32 s44, 7, 0
    s_sub_u32 s56, s56, s44
    s_add_u32 s57, s56, 1
    s_cmp_ge_u32 s57, 7
    s_cselect_b32 s44, 7, 0
    s_sub_u32 s57, s57, s44
    s_add_u32 s58, s57, 1
    s_cmp_ge_u32 s58, 7
    s_cselect_b32 s44, 7, 0
    s_sub_u32 s58, s58, s44
    s_add_u32 s59, s58, 1
    s_cmp_ge_u32 s59, 7
    s_cselect_b32 s44, 7, 0
    s_sub_u32 s59, s59, s44
    s_add_u32 s60, s59, 1
    s_cmp_ge_u32 s60, 7
    s_cselect_b32 s44, 7, 0
    s_sub_u32 s60, s60, s44
    s_add_u32 s61, s60, 1
    s_cmp_ge_u32 s61, 7
    s_cselect_b32 s44, 7, 0
    s_sub_u32 s61, s61, s44
    s_add_u32 s62, s61, 1
    s_cmp_ge_u32 s62, 7
    s_cselect_b32 s44, 7, 0
    s_sub_u32 s62, s62, s44
    s_lshl_b32 s56, s56, 13
    s_lshl_b32 s57, s57, 13
    s_lshl_b32 s58, s58, 13
    s_lshl_b32 s59, s59, 13
    s_lshl_b32 s60, s60, 13
    s_lshl_b32 s61, s61, 13
    s_lshl_b32 s62, s62, 13
k2_out2:
    s_setprio 2
    s_lshr_b32 s50, s32, 1
    s_and_b32 s51, s32, 1
    v_lshlrev_b32 v4, 4, v1
    s_lshl_b32 s49, s51, 7
    s_lshl_b32 s44, s38, 1
    s_add_u32 s51, s51, s44
    s_mul_i32 s52, s51, 90112
    s_add_u32 s52, s52, 20971520
    s_lshl_b32 s44, s50, 11
    s_add_u32 s52, s52, s44
    s_add_u32 s63, s52, 32768
    s_mov_b32 s53, 0
    s_sleep 16
    s_add_u32 s72, s63, s56
    buffer_load_dwordx4 v[60:63], v4, s[12:15], s72 offen offset:0 sc1
    buffer_load_dwordx4 v[64:67], v4, s[12:15], s72 offen offset:1024 sc1
    s_add_u32 s73, s63, s57
    buffer_load_dwordx4 v[68:71], v4, s[12:15], s73 offen offset:0 sc1
    buffer_load_dwordx4 v[72:75], v4, s[12:15], s73 offen offset:1024 sc1
    s_lshl_b32 s44, s38, 12
    s_add_u32 s49, s49, s44
    s_add_u32 s49, s49, 18877952
    v_lshrrev_b32 v126, 3, v1
    v_and_b32 v7, 7, v1
    v_bfe_u32 v8, v1, 4, 1
    v_lshlrev_b32 v9, 2, v8
    v_xor_b32 v7, v7, v9
    v_lshlrev_b32 v7, 4, v7
    v_lshl_add_u32 v5, v126, 10, v7
    v_bfe_u32 v126, v1, 2, 2
    v_lshl_add_u32 v126, v3, 3, v126
    v_and_b32 v7, 1, v1
    v_bfe_u32 v9, v1, 1, 1
    v_lshl_add_u32 v7, v7, 1, v9
    v_lshlrev_b32 v7, 3, v7
    v_lshl_add_u32 v7, v8, 5, v7
    v_bfe_u32 v9, v1, 3, 1
    v_lshl_add_u32 v7, v9, 6, v7
    v_lshl_add_u32 v126, v126, 7, v7
    s_lshl_b32 s44, s50, 5
    v_xor_b32 v126, s44, v126
    s_lshl_b32 s44, s50, 12
    v_add_u32 v126, s44, v126
    v_xor_b32 v124, 64, v126
    v_add_u32 v127, 0x8000, v126
    v_add_u32 v125, 0x8000, v124
    v_lshlrev_b32 v8, 2, v2
    s_lshl_b32 s46, s35, 7
    s_lshl_b32 s42, s32, 11
    s_lshl_b32 s40, s42, 3
    s_add_u32 s40, s40, s46
    v_lshlrev_b32 v9, 10, v2
    v_lshl_add_u32 v9, v3, 4, v9
    s_lshl_b32 s48, s51, 15
    s_add_u32 s48, s48, s46
    s_lshl_b32 s44, s50, 5
    s_add_u32 s48, s48, s44
    s_and_b32 s44, s32, 3
    s_lshl_b32 s44, s44, 12
    v_add_u32 v6, s44, v4
    s_add_u32 s74, s63, s58
    buffer_load_dwordx4 v[76:79], v4, s[12:15], s74 offen offset:0 sc1
    buffer_load_dwordx4 v[80:83], v4, s[12:15], s74 offen offset:1024 sc1
    s_add_u32 s75, s63, s59
    buffer_load_dwordx4 v[84:87], v4, s[12:15], s75 offen offset:0 sc1
    buffer_load_dwordx4 v[88:91], v4, s[12:15], s75 offen offset:1024 sc1
    buffer_load_dword v7, v8, s[12:15], s49 offen sc1
    ds_read_b64_tr_b16 v[12:13], v126 offset:0
    ds_read_b64_tr_b16 v[14:15], v126 offset:512
    ds_read_b64_tr_b16 v[16:17], v124 offset:0
    ds_read_b64_tr_b16 v[18:19], v124 offset:512
    ds_read_b64_tr_b16 v[20:21], v126 offset:2048
    ds_read_b64_tr_b16 v[22:23], v126 offset:2560
    ds_read_b64_tr_b16 v[24:25], v124 offset:2048
    ds_read_b64_tr_b16 v[26:27], v124 offset:2560
    s_waitcnt vmcnt(7)
    v_max3_u32 v10, v60, v61, v62
    v_max3_u32 v11, v63, v64, v65
    v_max3_u32 v10, v10, v66, v67
    v_max_u32 v10, v10, v11
    v_cmp_eq_u32 vcc, -1, v10
    s_mov_b32 s55, 0
    s_cbranch_vccnz k2_fx
k2_r0:
    s_waitcnt lgkmcnt(4)
    v_mfma_f32_32x32x16_bf16 v[28:43], v[12:15], v[60:63], 0
    v_mfma_f32_32x32x16_bf16 v[44:59], v[16:19], v[60:63], 0
    ds_read_b64_tr_b16 v[12:13], v126 offset:16384
    ds_read_b64_tr_b16 v[14:15], v126 offset:16896
    ds_read_b64_tr_b16 v[16:17], v124 offset:16384
    ds_read_b64_tr_b16 v[18:19], v124 offset:16896
    s_waitcnt lgkmcnt(4)
    v_mfma_f32_32x32x16_bf16 v[28:43], v[20:23], v[64:67], v[28:43]
    v_mfma_f32_32x32x16_bf16 v[44:59], v[24:27], v[64:67], v[44:59]
    s_nop 3
    s_add_u32 s72, s63, s60
    buffer_load_dwordx4 v[60:63], v4, s[12:15], s72 offen offset:0 sc1
    buffer_load_dwordx4 v[64:67], v4, s[12:15], s72 offen offset:1024 sc1
    ds_read_b64_tr_b16 v[20:21], v126 offset:18432
    ds_read_b64_tr_b16 v[22:23], v126 offset:18944
    ds_read_b64_tr_b16 v[24:25], v124 offset:18432
    ds_read_b64_tr_b16 v[26:27], v124 offset:18944
    s_waitcnt vmcnt(7)
    v_max3_u32 v10, v68, v69, v70
    v_max3_u32 v11, v71, v72, v73
    v_max3_u32 v10, v10, v74, v75
    v_max_u32 v10, v10, v11
    v_cmp_eq_u32 vcc, -1, v10
    s_mov_b32 s55, 33
    s_cbranch_vccnz k2_fx
k2_r1:
    s_waitcnt lgkmcnt(4)
    v_mfma_f32_32x32x16_bf16 v[28:43], v[12:15], v[68:71], v[28:43]
    v_mfma_f32_32x32x16_bf16 v[44:59], v[16:19], v[68:71], v[44:59]
    s_waitcnt lgkmcnt(0)
    v_mfma_f32_32x32x16_bf16 v[28:43], v[20:23], v[72:75], v[28:43]
    v_mfma_f32_32x32x16_bf16 v[44:59], v[24:27], v[72:75], v[44:59]
    s_barrier
    s_lshl_b32 s43, s61, 4
    s_add_u32 s43, s43, s40
    s_add_u32 m0, s42, 0
    s_add_u32 s41, s43, 0
    buffer_load_dwordx4 v5, s[64:67], s41 offen lds
    s_add_u32 m0, s42, 1024
    s_add_u32 s41, s43, 8192
    buffer_load_dwordx4 v5, s[64:67], s41 offen lds
    s_lshl_b32 s43, s62, 4
    s_add_u32 s43, s43, s40
    s_add_u32 m0, s42, 16384
    s_add_u32 s41, s43, 0
    buffer_load_dwordx4 v5, s[64:67], s41 offen lds
    s_add_u32 m0, s42, 17408
    s_add_u32 s41, s43, 8192
    buffer_load_dwordx4 v5, s[64:67], s41 offen lds
    s_add_u32 s73, s63, s61
    buffer_load_dwordx4 v[68:71], v4, s[12:15], s73 offen offset:0 sc1
    buffer_load_dwordx4 v[72:75], v4, s[12:15], s73 offen offset:1024 sc1
    ds_read_b64_tr_b16 v[12:13], v127 offset:0
    ds_read_b64_tr_b16 v[14:15], v127 offset:512
    ds_read_b64_tr_b16 v[16:17], v125 offset:0
    ds_read_b64_tr_b16 v[18:19], v125 offset:512
    ds_read_b64_tr_b16 v[20:21], v127 offset:2048
    ds_read_b64_tr_b16 v[22:23], v127 offset:2560
    ds_read_b64_tr_b16 v[24:25], v125 offset:2048
    ds_read_b64_tr_b16 v[26:27], v125 offset:2560
    s_waitcnt vmcnt(11)
    v_max3_u32 v10, v76, v77, v78
    v_max3_u32 v11, v79, v80, v81
    v_max3_u32 v10, v10, v82, v83
    v_max_u32 v10, v10, v11
    v_cmp_eq_u32 vcc, -1, v10
    s_mov_b32 s55, 66
    s_cbranch_vccnz k2_fx
k2_r2:
    s_waitcnt lgkmcnt(4)
    v_mfma_f32_32x32x16_bf16 v[28:43], v[12:15], v[76:79], v[28:43]
    v_mfma_f32_32x32x16_bf16 v[44:59], v[16:19], v[76:79], v[44:59]
    ds_read_b64_tr_b16 v[12:13], v127 offset:16384
    ds_read_b64_tr_b16 v[14:15], v127 offset:16896
    ds_read_b64_tr_b16 v[16:17], v125 offset:16384
    ds_read_b64_tr_b16 v[18:19], v125 offset:16896
    s_waitcnt lgkmcnt(4)
    v_mfma_f32_32x32x16_bf16 v[28:43], v[20:23], v[80:83], v[28:43]
    v_mfma_f32_32x32x16_bf16 v[44:59], v[24:27], v[80:83], v[44:59]
    s_nop 3
    s_add_u32 s74, s63, s62
    buffer_load_dwordx4 v[76:79], v4, s[12:15], s74 offen offset:0 sc1
    buffer_load_dwordx4 v[80:83], v4, s[12:15], s74 offen offset:1024 sc1
    ds_read_b64_tr_b16 v[20:21], v127 offset:18432
    ds_read_b64_tr_b16 v[22:23], v127 offset:18944
    ds_read_b64_tr_b16 v[24:25], v125 offset:18432
    ds_read_b64_tr_b16 v[26:27], v125 offset:18944
    s_waitcnt vmcnt(11)
    v_max3_u32 v10, v84, v85, v86
    v_max3_u32 v11, v87, v88, v89
    v_max3_u32 v10, v10, v90, v91
    v_max_u32 v10, v10, v11
    v_cmp_eq_u32 vcc, -1, v10
    s_mov_b32 s55, 99
    s_cbranch_vccnz k2_fx
k2_r3:
    s_waitcnt lgkmcnt(4)
    v_mfma_f32_32x32x16_bf16 v[28:43], v[12:15], v[84:87], v[28:43]
    v_mfma_f32_32x32x16_bf16 v[44:59], v[16:19], v[84:87], v[44:59]
    s_waitcnt lgkmcnt(0)
    v_mfma_f32_32x32x16_bf16 v[28:43], v[20:23], v[88:91], v[28:43]
    v_mfma_f32_32x32x16_bf16 v[44:59], v[24:27], v[88:91], v[44:59]
    s_barrier
    s_add_u32 m0, s42, 32768
    s_add_u32 s41, s40, 0
    buffer_load_dwordx4 v5, s[68:71], s41 offen lds
    s_add_u32 m0, s42, 33792
    s_add_u32 s41, s40, 8192
    buffer_load_dwordx4 v5, s[68:71], s41 offen lds
    s_add_u32 m0, s42, 49152
    s_add_u32 s41, s40, 131072
    buffer_load_dwordx4 v5, s[68:71], s41 offen lds
    s_add_u32 m0, s42, 50176
    s_add_u32 s41, s40, 139264
    buffer_load_dwordx4 v5, s[68:71], s41 offen lds
    s_add_u32 s75, s52, 0
    buffer_load_dwordx4 v[84:87], v4, s[12:15], s75 offen offset:0 sc1
    buffer_load_dwordx4 v[88:91], v4, s[12:15], s75 offen offset:1024 sc1
    ds_read_b64_tr_b16 v[12:13], v127 offset:32768
    ds_read_b64_tr_b16 v[14:15], v127 offset:33280
    ds_read_b64_tr_b16 v[16:17], v125 offset:32768
    ds_read_b64_tr_b16 v[18:19], v125 offset:33280
    ds_read_b64_tr_b16 v[20:21], v127 offset:34816
    ds_read_b64_tr_b16 v[22:23], v127 offset:35328
    ds_read_b64_tr_b16 v[24:25], v125 offset:34816
    ds_read_b64_tr_b16 v[26:27], v125 offset:35328
    s_waitcnt vmcnt(14)
    v_max3_u32 v10, v60, v61, v62
    v_max3_u32 v11, v63, v64, v65
    v_max3_u32 v10, v10, v66, v67
    v_max_u32 v10, v10, v11
    v_cmp_eq_u32 vcc, -1, v10
    s_mov_b32 s55, 128
    s_cbranch_vccnz k2_fx
k2_r4:
    s_waitcnt lgkmcnt(4)
    v_mfma_f32_32x32x16_bf16 v[28:43], v[12:15], v[60:63], v[28:43]
    v_mfma_f32_32x32x16_bf16 v[44:59], v[16:19], v[60:63], v[44:59]
    s_waitcnt lgkmcnt(0)
    v_mfma_f32_32x32x16_bf16 v[28:43], v[20:23], v[64:67], v[28:43]
    v_mfma_f32_32x32x16_bf16 v[44:59], v[24:27], v[64:67], v[44:59]
    s_waitcnt vmcnt(10)
    s_barrier
    s_add_u32 m0, s42, 65536
    s_add_u32 s41, s40, 262144
    buffer_load_dwordx4 v5, s[68:71], s41 offen lds
    s_add_u32 m0, s42, 66560
    s_add_u32 s41, s40, 270336
    buffer_load_dwordx4 v5, s[68:71], s41 offen lds
    s_add_u32 s72, s52, 8192
    buffer_load_dwordx4 v[60:63], v4, s[12:15], s72 offen offset:0 sc1
    buffer_load_dwordx4 v[64:67], v4, s[12:15], s72 offen offset:1024 sc1
    ds_read_b64_tr_b16 v[12:13], v126 offset:0
    ds_read_b64_tr_b16 v[14:15], v126 offset:512
    ds_read_b64_tr_b16 v[16:17], v124 offset:0
    ds_read_b64_tr_b16 v[18:19], v124 offset:512
    ds_read_b64_tr_b16 v[20:21], v126 offset:2048
    ds_read_b64_tr_b16 v[22:23], v126 offset:2560
    ds_read_b64_tr_b16 v[24:25], v124 offset:2048
    ds_read_b64_tr_b16 v[26:27], v124 offset:2560
    s_waitcnt vmcnt(12)
    v_max3_u32 v10, v68, v69, v70
    v_max3_u32 v11, v71, v72, v73
    v_max3_u32 v10, v10, v74, v75
    v_max_u32 v10, v10, v11
    v_cmp_eq_u32 vcc, -1, v10
    s_mov_b32 s55, 161
    s_cbranch_vccnz k2_fx
k2_r5:
    s_waitcnt lgkmcnt(4)
    v_mfma_f32_32x32x16_bf16 v[28:43], v[12:15], v[68:71], v[28:43]
    v_mfma_f32_32x32x16_bf16 v[44:59], v[16:19], v[68:71], v[44:59]
    ds_read_b64_tr_b16 v[12:13], v126 offset:16384
    ds_read_b64_tr_b16 v[14:15], v126 offset:16896
    ds_read_b64_tr_b16 v[16:17], v124 offset:16384
    ds_read_b64_tr_b16 v[18:19], v124 offset:16896
    s_waitcnt lgkmcnt(4)
    v_mfma_f32_32x32x16_bf16 v[28:43], v[20:23], v[72:75], v[28:43]
    v_mfma_f32_32x32x16_bf16 v[44:59], v[24:27], v[72:75], v[44:59]
    s_nop 3
    s_add_u32 s73, s52, 16384
    buffer_load_dwordx4 v[68:71], v4, s[12:15], s73 offen offset:0 sc1
    buffer_load_dwordx4 v[72:75], v4, s[12:15], s73 offen offset:1024 sc1
    ds_read_b64_tr_b16 v[20:21], v126 offset:18432
    ds_read_b64_tr_b16 v[22:23], v126 offset:18944
    ds_read_b64_tr_b16 v[24:25], v124 offset:18432
    ds_read_b64_tr_b16 v[26:27], v124 offset:18944
    s_waitcnt vmcnt(12)
    v_max3_u32 v10, v76, v77, v78
    v_max3_u32 v11, v79, v80, v81
    v_max3_u32 v10, v10, v82, v83
    v_max_u32 v10, v10, v11
    v_cmp_eq_u32 vcc, -1, v10
    s_mov_b32 s55, 194
    s_cbranch_vccnz k2_fx
k2_r6:
    s_waitcnt lgkmcnt(4)
    v_mfma_f32_32x32x16_bf16 v[28:43], v[12:15], v[76:79], v[28:43]
    v_mfma_f32_32x32x16_bf16 v[44:59], v[16:19], v[76:79], v[44:59]
    s_waitcnt lgkmcnt(0)
    v_mfma_f32_32x32x16_bf16 v[28:43], v[20:23], v[80:83], v[28:43]
    v_mfma_f32_32x32x16_bf16 v[44:59], v[24:27], v[80:83], v[44:59]
    s_waitcnt vmcnt(8)
    s_barrier
    s_add_u32 m0, s42, 0
    s_add_u32 s41, s40, 393216
    buffer_load_dwordx4 v5, s[68:71], s41 offen lds
    s_add_u32 m0, s42, 1024
    s_add_u32 s41, s40, 401408
    buffer_load_dwordx4 v5, s[68:71], s41 offen lds
    s_add_u32 s74, s52, 24576
    buffer_load_dwordx4 v[76:79], v4, s[12:15], s74 offen offset:0 sc1
    buffer_load_dwordx4 v[80:83], v4, s[12:15], s74 offen offset:1024 sc1
    ds_read_b64_tr_b16 v[92:93], v127 offset:0
    ds_read_b64_tr_b16 v[94:95], v127 offset:512
    ds_read_b64_tr_b16 v[96:97], v125 offset:0
    ds_read_b64_tr_b16 v[98:99], v125 offset:512
    ds_read_b64_tr_b16 v[100:101], v127 offset:2048
    ds_read_b64_tr_b16 v[102:103], v127 offset:2560
    ds_read_b64_tr_b16 v[104:105], v125 offset:2048
    ds_read_b64_tr_b16 v[106:107], v125 offset:2560
    ds_read_b64_tr_b16 v[108:109], v127 offset:16384
    ds_read_b64_tr_b16 v[110:111], v127 offset:16896
    ds_read_b64_tr_b16 v[112:113], v125 offset:16384
    ds_read_b64_tr_b16 v[114:115], v125 offset:16896
    ds_read_b64_tr_b16 v[116:117], v127 offset:18432
    ds_read_b64_tr_b16 v[118:119], v127 offset:18944
    ds_read_b64_tr_b16 v[120:121], v125 offset:18432
    ds_read_b64_tr_b16 v[122:123], v125 offset:18944
k2_gc:
    v_cmp_eq_u32 vcc, -1, v7
    s_mov_b32 s54, 15
    s_cbranch_vccnz k2_fg
k2_gr:
    v_sub_f32 v8, 1.0, v7
    s_and_b32 s44, s32, 1
    s_mul_i32 s44, s44, 24576
    s_add_u32 s44, s44, 16384
    s_xor_b32 s45, s50, 0
    s_mul_i32 s45, s45, 6144
    s_add_u32 s45, s45, s44
    v_add_u32 v6, s45, v4
    s_xor_b32 s45, s50, 1
    s_mul_i32 s45, s45, 6144
    s_add_u32 s45, s45, s44
    v_add_u32 v2, s45, v4
    s_xor_b32 s45, s50, 2
    s_mul_i32 s45, s45, 6144
    s_add_u32 s45, s45, s44
    v_add_u32 v3, s45, v4
    s_xor_b32 s45, s50, 3
    s_mul_i32 s45, s45, 6144
    s_add_u32 s45, s45, s44
    v_add_u32 v5, s45, v4
    v_pk_mul_f32 v[28:29], v[28:29], v[8:9] op_sel_hi:[1,0]
    v_pk_mul_f32 v[30:31], v[30:31], v[8:9] op_sel_hi:[1,0]
    v_pk_mul_f32 v[32:33], v[32:33], v[8:9] op_sel_hi:[1,0]
    v_pk_mul_f32 v[34:35], v[34:35], v[8:9] op_sel_hi:[1,0]
    v_pk_mul_f32 v[36:37], v[36:37], v[8:9] op_sel_hi:[1,0]
    v_pk_mul_f32 v[38:39], v[38:39], v[8:9] op_sel_hi:[1,0]
    v_pk_mul_f32 v[40:41], v[40:41], v[8:9] op_sel_hi:[1,0]
    v_pk_mul_f32 v[42:43], v[42:43], v[8:9] op_sel_hi:[1,0]
    v_pk_mul_f32 v[44:45], v[44:45], v[8:9] op_sel_hi:[1,0]
    v_pk_mul_f32 v[46:47], v[46:47], v[8:9] op_sel_hi:[1,0]
    v_pk_mul_f32 v[48:49], v[48:49], v[8:9] op_sel_hi:[1,0]
    v_pk_mul_f32 v[50:51], v[50:51], v[8:9] op_sel_hi:[1,0]
    v_pk_mul_f32 v[52:53], v[52:53], v[8:9] op_sel_hi:[1,0]
    v_pk_mul_f32 v[54:55], v[54:55], v[8:9] op_sel_hi:[1,0]
    v_pk_mul_f32 v[56:57], v[56:57], v[8:9] op_sel_hi:[1,0]
    v_pk_mul_f32 v[58:59], v[58:59], v[8:9] op_sel_hi:[1,0]
    s_waitcnt vmcnt(10)
    v_max3_u32 v10, v84, v85, v86
    v_max3_u32 v11, v87, v88, v89
    v_max3_u32 v10, v10, v90, v91
    v_max_u32 v10, v10, v11
    v_cmp_eq_u32 vcc, -1, v10
    s_cbranch_vccnz k2_s0
    s_waitcnt lgkmcnt(12)
    v_mfma_f32_32x32x16_bf16 v[28:43], v[92:95], v[84:87], v[28:43]
    v_mfma_f32_32x32x16_bf16 v[44:59], v[96:99], v[84:87], v[44:59]
    s_waitcnt lgkmcnt(8)
    v_mfma_f32_32x32x16_bf16 v[28:43], v[100:103], v[88:91], v[28:43]
    v_mfma_f32_32x32x16_bf16 v[44:59], v[104:107], v[88:91], v[44:59]
    s_bitset0_b32 s54, 0
k2_s0:
    s_waitcnt vmcnt(6)
    v_max3_u32 v10, v60, v61, v62
    v_max3_u32 v11, v63, v64, v65
    v_max3_u32 v10, v10, v66, v67
    v_max_u32 v10, v10, v11
    v_cmp_eq_u32 vcc, -1, v10
    s_cbranch_vccnz k2_s1
    s_waitcnt lgkmcnt(4)
    v_mfma_f32_32x32x16_bf16 v[28:43], v[108:111], v[60:63], v[28:43]
    v_mfma_f32_32x32x16_bf16 v[44:59], v[112:115], v[60:63], v[44:59]
    s_waitcnt lgkmcnt(0)
    v_mfma_f32_32x32x16_bf16 v[28:43], v[116:119], v[64:67], v[28:43]
    v_mfma_f32_32x32x16_bf16 v[44:59], v[120:123], v[64:67], v[44:59]
    s_bitset0_b32 s54, 1
k2_s1:
    s_waitcnt vmcnt(2)
    s_waitcnt lgkmcnt(0)
    s_barrier
    ds_read_b64_tr_b16 v[12:13], v127 offset:32768
    ds_read_b64_tr_b16 v[14:15], v127 offset:33280
    ds_read_b64_tr_b16 v[16:17], v125 offset:32768
    ds_read_b64_tr_b16 v[18:19], v125 offset:33280
    ds_read_b64_tr_b16 v[20:21], v127 offset:34816
    ds_read_b64_tr_b16 v[22:23], v127 offset:35328
    ds_read_b64_tr_b16 v[24:25], v125 offset:34816
    ds_read_b64_tr_b16 v[26:27], v125 offset:35328
    v_max3_u32 v10, v68, v69, v70
    v_max3_u32 v11, v71, v72, v73
    v_max3_u32 v10, v10, v74, v75
    v_max_u32 v10, v10, v11
    v_cmp_eq_u32 vcc, -1, v10
    s_cbranch_vccnz k2_s2
    s_waitcnt lgkmcnt(4)
    v_mfma_f32_32x32x16_bf16 v[28:43], v[12:15], v[68:71], v[28:43]
    v_mfma_f32_32x32x16_bf16 v[44:59], v[16:19], v[68:71], v[44:59]
    ds_read_b64_tr_b16 v[12:13], v126 offset:0
    ds_read_b64_tr_b16 v[14:15], v126 offset:512
    ds_read_b64_tr_b16 v[16:17], v124 offset:0
    ds_read_b64_tr_b16 v[18:19], v124 offset:512
    s_waitcnt lgkmcnt(4)
    v_mfma_f32_32x32x16_bf16 v[28:43], v[20:23], v[72:75], v[28:43]
    v_mfma_f32_32x32x16_bf16 v[44:59], v[24:27], v[72:75], v[44:59]
    ds_read_b64_tr_b16 v[20:21], v126 offset:2048
    ds_read_b64_tr_b16 v[22:23], v126 offset:2560
    ds_read_b64_tr_b16 v[24:25], v124 offset:2048
    ds_read_b64_tr_b16 v[26:27], v124 offset:2560
    s_bitset0_b32 s54, 2
k2_n2:
    s_waitcnt vmcnt(0)
    v_max3_u32 v10, v76, v77, v78
    v_max3_u32 v11, v79, v80, v81
    v_max3_u32 v10, v10, v82, v83
    v_max_u32 v10, v10, v11
    v_cmp_eq_u32 vcc, -1, v10
    s_cbranch_vccnz k2_s3
    s_waitcnt lgkmcnt(4)
    v_mfma_f32_32x32x16_bf16 v[28:43], v[12:15], v[76:79], v[28:43]
    v_mfma_f32_32x32x16_bf16 v[44:59], v[16:19], v[76:79], v[44:59]
    s_waitcnt lgkmcnt(0)
    v_mfma_f32_32x32x16_bf16 v[28:43], v[20:23], v[80:83], v[28:43]
    v_mfma_f32_32x32x16_bf16 v[44:59], v[24:27], v[80:83], v[44:59]
    s_bitset0_b32 s54, 3
k2_n3:
    s_cmp_lg_u32 s54, 0
    s_cbranch_scc1 k2_s3
k2_fin:
    s_nop 7
    s_nop 1
    ds_write_b128 v2, v[36:39] offset:0
    ds_write_b128 v2, v[40:43] offset:1024
    s_nop 1
    ds_write_b128 v3, v[44:47] offset:2048
    ds_write_b128 v3, v[48:51] offset:3072
    ds_write_b128 v5, v[52:55] offset:4096
    ds_write_b128 v5, v[56:59] offset:5120
    s_waitcnt lgkmcnt(0)
    s_barrier
    ds_read_b128 v[92:95], v6 offset:0
    ds_read_b128 v[96:99], v6 offset:1024
    ds_read_b128 v[100:103], v6 offset:2048
    ds_read_b128 v[104:107], v6 offset:3072
    ds_read_b128 v[108:111], v6 offset:4096
    ds_read_b128 v[112:115], v6 offset:5120
    s_waitcnt lgkmcnt(4)
    v_pk_add_f32 v[28:29], v[28:29], v[92:93]
    v_pk_add_f32 v[30:31], v[30:31], v[94:95]
    v_pk_add_f32 v[32:33], v[32:33], v[96:97]
    v_pk_add_f32 v[34:35], v[34:35], v[98:99]
    s_waitcnt lgkmcnt(2)
    v_pk_add_f32 v[28:29], v[28:29], v[100:101]
    v_pk_add_f32 v[30:31], v[30:31], v[102:103]
    v_pk_add_f32 v[32:33], v[32:33], v[104:105]
    v_pk_add_f32 v[34:35], v[34:35], v[106:107]
    s_waitcnt lgkmcnt(0)
    v_pk_add_f32 v[28:29], v[28:29], v[108:109]
    v_pk_add_f32 v[30:31], v[30:31], v[110:111]
    v_pk_add_f32 v[32:33], v[32:33], v[112:113]
    v_pk_add_f32 v[34:35], v[34:35], v[114:115]
    v_cvt_pk_bf16_f32 v36, v28, v29
    v_cvt_pk_bf16_f32 v37, v30, v31
    v_cvt_pk_bf16_f32 v38, v32, v33
    v_cvt_pk_bf16_f32 v39, v34, v35
    buffer_store_dwordx4 v[36:39], v9, s[4:7], s48 offen
    s_endpgm
k2_s2:
    ds_read_b64_tr_b16 v[12:13], v126 offset:0
    ds_read_b64_tr_b16 v[14:15], v126 offset:512
    ds_read_b64_tr_b16 v[16:17], v124 offset:0
    ds_read_b64_tr_b16 v[18:19], v124 offset:512
    ds_read_b64_tr_b16 v[20:21], v126 offset:2048
    ds_read_b64_tr_b16 v[22:23], v126 offset:2560
    ds_read_b64_tr_b16 v[24:25], v124 offset:2048
    ds_read_b64_tr_b16 v[26:27], v124 offset:2560
    s_branch k2_n2
k2_s3:
    s_mov_b32 s55, 3
k2_ox:
    s_sleep 2
    s_bitcmp1_b32 s54, 0
    s_cbranch_scc0 k2_oy0
    v_max3_u32 v10, v84, v85, v86
    v_max_u32 v10, v10, v87
    v_cmp_eq_u32 vcc, -1, v10
    s_cbranch_vccz k2_oz00
    buffer_load_dwordx4 v[84:87], v4, s[12:15], s75 offen offset:0 sc1
k2_oz00:
    v_max3_u32 v10, v88, v89, v90
    v_max_u32 v10, v10, v91
    v_cmp_eq_u32 vcc, -1, v10
    s_cbranch_vccz k2_oz01
    buffer_load_dwordx4 v[88:91], v4, s[12:15], s75 offen offset:1024 sc1
k2_oz01:
k2_oy0:
    s_bitcmp1_b32 s54, 1
    s_cbranch_scc0 k2_oy1
    v_max3_u32 v10, v60, v61, v62
    v_max_u32 v10, v10, v63
    v_cmp_eq_u32 vcc, -1, v10
    s_cbranch_vccz k2_oz10
    buffer_load_dwordx4 v[60:63], v4, s[12:15], s72 offen offset:0 sc1
k2_oz10:
    v_max3_u32 v10, v64, v65, v66
    v_max_u32 v10, v10, v67
    v_cmp_eq_u32 vcc, -1, v10
    s_cbranch_vccz k2_oz11
    buffer_load_dwordx4 v[64:67], v4, s[12:15], s72 offen offset:1024 sc1
k2_oz11:
k2_oy1:
    s_bitcmp1_b32 s54, 2
    s_cbranch_scc0 k2_oy2
    v_max3_u32 v10, v68, v69, v70
    v_max_u32 v10, v10, v71
    v_cmp_eq_u32 vcc, -1, v10
    s_cbranch_vccz k2_oz20
    buffer_load_dwordx4 v[68:71], v4, s[12:15], s73 offen offset:0 sc1
k2_oz20:
    v_max3_u32 v10, v72, v73, v74
    v_max_u32 v10, v10, v75
    v_cmp_eq_u32 vcc, -1, v10
    s_cbranch_vccz k2_oz21
    buffer_load_dwordx4 v[72:75], v4, s[12:15], s73 offen offset:1024 sc1
k2_oz21:
k2_oy2:
    s_bitcmp1_b32 s54, 3
    s_cbranch_scc0 k2_oy3
    v_max3_u32 v10, v76, v77, v78
    v_max_u32 v10, v10, v79
    v_cmp_eq_u32 vcc, -1, v10
    s_cbranch_vccz k2_oz30
    buffer_load_dwordx4 v[76:79], v4, s[12:15], s74 offen offset:0 sc1
k2_oz30:
    v_max3_u32 v10, v80, v81, v82
    v_max_u32 v10, v10, v83
    v_cmp_eq_u32 vcc, -1, v10
    s_cbranch_vccz k2_oz31
    buffer_load_dwordx4 v[80:83], v4, s[12:15], s74 offen offset:1024 sc1
k2_oz31:
k2_oy3:
    s_bitcmp1_b32 s54, s55
    s_cbranch_scc1 k2_ow
    s_xor_b32 s45, s55, 1
    s_bitcmp1_b32 s54, s45
    s_cbranch_scc0 k2_ow
    s_mov_b32 s55, s45
    s_cmp_eq_u32 s55, 2
    s_cbranch_scc0 k2_ov
    ds_read_b64_tr_b16 v[12:13], v127 offset:32768
    ds_read_b64_tr_b16 v[14:15], v127 offset:33280
    ds_read_b64_tr_b16 v[16:17], v125 offset:32768
    ds_read_b64_tr_b16 v[18:19], v125 offset:33280
    ds_read_b64_tr_b16 v[20:21], v127 offset:34816
    ds_read_b64_tr_b16 v[22:23], v127 offset:35328
    ds_read_b64_tr_b16 v[24:25], v125 offset:34816
    ds_read_b64_tr_b16 v[26:27], v125 offset:35328
    s_branch k2_ow
k2_ov:
    ds_read_b64_tr_b16 v[12:13], v126 offset:0
    ds_read_b64_tr_b16 v[14:15], v126 offset:512
    ds_read_b64_tr_b16 v[16:17], v124 offset:0
    ds_read_b64_tr_b16 v[18:19], v124 offset:512
    ds_read_b64_tr_b16 v[20:21], v126 offset:2048
    ds_read_b64_tr_b16 v[22:23], v126 offset:2560
    ds_read_b64_tr_b16 v[24:25], v124 offset:2048
    ds_read_b64_tr_b16 v[26:27], v124 offset:2560
k2_ow:
    s_add_u32 s53, s53, 1
    s_cmp_ge_u32 s53, 0x10000
    s_cbranch_scc1 k2_fin
    s_waitcnt vmcnt(0) lgkmcnt(0)
    s_bitcmp1_b32 s54, 0
    s_cbranch_scc0 k2_ou0
    v_max3_u32 v10, v84, v85, v86
    v_max3_u32 v11, v87, v88, v89
    v_max3_u32 v10, v10, v90, v91
    v_max_u32 v10, v10, v11
    v_cmp_eq_u32 vcc, -1, v10
    s_cbranch_vccnz k2_ou0
    v_mfma_f32_32x32x16_bf16 v[28:43], v[92:95], v[84:87], v[28:43]
    v_mfma_f32_32x32x16_bf16 v[44:59], v[96:99], v[84:87], v[44:59]
    v_mfma_f32_32x32x16_bf16 v[28:43], v[100:103], v[88:91], v[28:43]
    v_mfma_f32_32x32x16_bf16 v[44:59], v[104:107], v[88:91], v[44:59]
    s_bitset0_b32 s54, 0
k2_ou0:
    s_bitcmp1_b32 s54, 1
    s_cbranch_scc0 k2_ou1
    v_max3_u32 v10, v60, v61, v62
    v_max3_u32 v11, v63, v64, v65
    v_max3_u32 v10, v10, v66, v67
    v_max_u32 v10, v10, v11
    v_cmp_eq_u32 vcc, -1, v10
    s_cbranch_vccnz k2_ou1
    v_mfma_f32_32x32x16_bf16 v[28:43], v[108:111], v[60:63], v[28:43]
    v_mfma_f32_32x32x16_bf16 v[44:59], v[112:115], v[60:63], v[44:59]
    v_mfma_f32_32x32x16_bf16 v[28:43], v[116:119], v[64:67], v[28:43]
    v_mfma_f32_32x32x16_bf16 v[44:59], v[120:123], v[64:67], v[44:59]
    s_bitset0_b32 s54, 1
k2_ou1:
    s_bitcmp1_b32 s54, 2
    s_cbranch_scc0 k2_ou2
    v_max3_u32 v10, v68, v69, v70
    v_max3_u32 v11, v71, v72, v73
    v_max3_u32 v10, v10, v74, v75
    v_max_u32 v10, v10, v11
    v_cmp_eq_u32 vcc, -1, v10
    s_cbranch_vccnz k2_ou2
    s_cmp_eq_u32 s55, 2
    s_cbranch_scc1 k2_ot2
    ds_read_b64_tr_b16 v[12:13], v127 offset:32768
    ds_read_b64_tr_b16 v[14:15], v127 offset:33280
    ds_read_b64_tr_b16 v[16:17], v125 offset:32768
    ds_read_b64_tr_b16 v[18:19], v125 offset:33280
    ds_read_b64_tr_b16 v[20:21], v127 offset:34816
    ds_read_b64_tr_b16 v[22:23], v127 offset:35328
    ds_read_b64_tr_b16 v[24:25], v125 offset:34816
    ds_read_b64_tr_b16 v[26:27], v125 offset:35328
    s_mov_b32 s55, 2
    s_waitcnt lgkmcnt(0)
k2_ot2:
    v_mfma_f32_32x32x16_bf16 v[28:43], v[12:15], v[68:71], v[28:43]
    v_mfma_f32_32x32x16_bf16 v[44:59], v[16:19], v[68:71], v[44:59]
    v_mfma_f32_32x32x16_bf16 v[28:43], v[20:23], v[72:75], v[28:43]
    v_mfma_f32_32x32x16_bf16 v[44:59], v[24:27], v[72:75], v[44:59]
    s_bitset0_b32 s54, 2
k2_ou2:
    s_bitcmp1_b32 s54, 3
    s_cbranch_scc0 k2_ou3
    v_max3_u32 v10, v76, v77, v78
    v_max3_u32 v11, v79, v80, v81
    v_max3_u32 v10, v10, v82, v83
    v_max_u32 v10, v10, v11
    v_cmp_eq_u32 vcc, -1, v10
    s_cbranch_vccnz k2_ou3
    s_cmp_eq_u32 s55, 3
    s_cbranch_scc1 k2_ot3
    ds_read_b64_tr_b16 v[12:13], v126 offset:0
    ds_read_b64_tr_b16 v[14:15], v126 offset:512
    ds_read_b64_tr_b16 v[16:17], v124 offset:0
    ds_read_b64_tr_b16 v[18:19], v124 offset:512
    ds_read_b64_tr_b16 v[20:21], v126 offset:2048
    ds_read_b64_tr_b16 v[22:23], v126 offset:2560
    ds_read_b64_tr_b16 v[24:25], v124 offset:2048
    ds_read_b64_tr_b16 v[26:27], v124 offset:2560
    s_mov_b32 s55, 3
    s_waitcnt lgkmcnt(0)
k2_ot3:
    v_mfma_f32_32x32x16_bf16 v[28:43], v[12:15], v[76:79], v[28:43]
    v_mfma_f32_32x32x16_bf16 v[44:59], v[16:19], v[76:79], v[44:59]
    v_mfma_f32_32x32x16_bf16 v[28:43], v[20:23], v[80:83], v[28:43]
    v_mfma_f32_32x32x16_bf16 v[44:59], v[24:27], v[80:83], v[44:59]
    s_bitset0_b32 s54, 3
k2_ou3:
    s_cmp_lg_u32 s54, 0
    s_cbranch_scc0 k2_fin
    s_branch k2_ox
k2_fx:
    s_waitcnt vmcnt(0)
    s_mov_b32 s54, 0
    v_max3_u32 v10, v84, v85, v86
    v_max3_u32 v11, v87, v88, v89
    v_max3_u32 v10, v10, v90, v91
    v_max_u32 v10, v10, v11
    v_cmp_eq_u32 vcc, -1, v10
    s_cmp_lg_u64 vcc, 0
    s_addc_u32 s54, s54, s54
    v_max3_u32 v10, v76, v77, v78
    v_max3_u32 v11, v79, v80, v81
    v_max3_u32 v10, v10, v82, v83
    v_max_u32 v10, v10, v11
    v_cmp_eq_u32 vcc, -1, v10
    s_cmp_lg_u64 vcc, 0
    s_addc_u32 s54, s54, s54
    v_max3_u32 v10, v68, v69, v70
    v_max3_u32 v11, v71, v72, v73
    v_max3_u32 v10, v10, v74, v75
    v_max_u32 v10, v10, v11
    v_cmp_eq_u32 vcc, -1, v10
    s_cmp_lg_u64 vcc, 0
    s_addc_u32 s54, s54, s54
    v_max3_u32 v10, v60, v61, v62
    v_max3_u32 v11, v63, v64, v65
    v_max3_u32 v10, v10, v66, v67
    v_max_u32 v10, v10, v11
    v_cmp_eq_u32 vcc, -1, v10
    s_cmp_lg_u64 vcc, 0
    s_addc_u32 s54, s54, s54
    s_add_u32 s53, s53, 1
    s_cmp_ge_u32 s53, 0x10000
    s_cselect_b32 s54, 0, s54
    s_bitcmp1_b32 s54, s55
    s_cbranch_scc0 k2_fxx
    s_sleep 1
    s_bitcmp1_b32 s54, 0
    s_cbranch_scc0 k2_fx0
    buffer_load_dwordx4 v[60:63], v4, s[12:15], s72 offen offset:0 sc1
    buffer_load_dwordx4 v[64:67], v4, s[12:15], s72 offen offset:1024 sc1
k2_fx0:
    s_bitcmp1_b32 s54, 1
    s_cbranch_scc0 k2_fx1
    buffer_load_dwordx4 v[68:71], v4, s[12:15], s73 offen offset:0 sc1
    buffer_load_dwordx4 v[72:75], v4, s[12:15], s73 offen offset:1024 sc1
k2_fx1:
    s_bitcmp1_b32 s54, 2
    s_cbranch_scc0 k2_fx2
    buffer_load_dwordx4 v[76:79], v4, s[12:15], s74 offen offset:0 sc1
    buffer_load_dwordx4 v[80:83], v4, s[12:15], s74 offen offset:1024 sc1
k2_fx2:
    s_bitcmp1_b32 s54, 3
    s_cbranch_scc0 k2_fx3
    buffer_load_dwordx4 v[84:87], v4, s[12:15], s75 offen offset:0 sc1
    buffer_load_dwordx4 v[88:91], v4, s[12:15], s75 offen offset:1024 sc1
k2_fx3:
    s_branch k2_fx
k2_fxx:
    s_cmp_lt_u32 s55, 32
    s_cbranch_scc1 k2_r0
    s_cmp_lt_u32 s55, 64
    s_cbranch_scc1 k2_r1
    s_cmp_lt_u32 s55, 96
    s_cbranch_scc1 k2_r2
    s_cmp_lt_u32 s55, 128
    s_cbranch_scc1 k2_r3
    s_cmp_lt_u32 s55, 160
    s_cbranch_scc1 k2_r4
    s_cmp_lt_u32 s55, 192
    s_cbranch_scc1 k2_r5
    s_branch k2_r6
k2_fg:
    s_add_u32 s53, s53, 1
    s_cmp_ge_u32 s53, 0x10000
    s_cbranch_scc1 k2_gr
    s_sleep 4
    buffer_load_dword v7, v8, s[12:15], s49 offen sc1
    s_waitcnt vmcnt(0)
    s_branch k2_gc
kf_end:
.section .rodata,"a"
.p2align 6
.amdhsa_kernel kf_kernel
  .amdhsa_next_free_vgpr 128
  .amdhsa_next_free_sgpr 96
  .amdhsa_accum_offset 128
  .amdhsa_group_segment_fixed_size 0
  .amdhsa_kernarg_size 96
  .amdhsa_user_sgpr_count 2
  .amdhsa_user_sgpr_kernarg_segment_ptr 1
  .amdhsa_system_sgpr_workgroup_id_x 1
.end_amdhsa_kernel
```
